```python
import torch

def _softmax(x, axis=-1):
    return torch.softmax(x, dim=axis)
def _gelu(x):
    return torch.nn.functional.gelu(x, approximate="tanh")
def _silu(x):
    return torch.nn.functional.silu(x)
def _sigmoid(x):
    return torch.sigmoid(x)
def _layernorm(x, axis=-1, eps=1e-5):
    m = x.mean(dim=axis, keepdim=True)
    v = x.var(dim=axis, keepdim=True, unbiased=False)
    return (x - m) / torch.sqrt(v + eps)
def _scatter_add(tgt, idx, src, axis=0):
    return tgt.clone().index_add_(axis, idx, src)
def _segment_sum(src, seg, n):
    out = torch.zeros((n,) + src.shape[1:], dtype=src.dtype)
    return out.index_add_(0, seg, src)
def _pad(x, pw):
    flat = tuple(v for pair in reversed(pw) for v in pair)
    return torch.nn.functional.pad(x, flat)

kernel_name = 'gated_mix__gqa_block_cached__swiglu_ffn__decode'

def setup_inputs():

    _w = (lambda a: (lambda t: t.to(torch.bfloat16) if t.is_floating_point() else t)(torch.as_tensor(a)))
    def _A_setup():
        B, Sq, D = 4, 1, 512
        Hq, Hkv, Sk, Dh = 32, 8, 4096, 128
        assert Hq % Hkv == 0, (Hq, Hkv)
        return {
            "x": _w((lambda *s: torch.randn(*s, dtype=torch.bfloat16) * 0.05)(B, Sq, D)),
            "k_cache": _w((lambda *s: torch.randn(*s, dtype=torch.bfloat16) * 6.4)(B, Hkv, Sk, Dh)),
            "v_cache": _w((lambda *s: torch.randn(*s, dtype=torch.bfloat16) * 0.2)(B, Hkv, Sk, Dh)),
            "wq": _w((lambda *s: torch.randn(*s, dtype=torch.bfloat16) * 6.4)(D, Hq * Dh) * (D ** -0.5)),
            "wo": _w((lambda *s: torch.randn(*s, dtype=torch.bfloat16) * 0.2)(Hq * Dh, D) * ((Hq * Dh) ** -0.5)),
        }
    _A_in = _A_setup()

    def _B_setup():
        B, S, D, F = 4, 1, 512, 1792
        return {
            "x": _w((lambda *s: torch.randn(*s, dtype=torch.bfloat16) * 0.05)(B, S, D)),
            "w_gate": _w((lambda *s: torch.randn(*s, dtype=torch.bfloat16) * 0.05)(D, F)),
            "w_up": _w((lambda *s: torch.randn(*s, dtype=torch.bfloat16) * 0.05)(D, F)),
            "w_down": _w((lambda *s: torch.randn(*s, dtype=torch.bfloat16) * 0.05)(F, D)),
        }
    _B_in = _B_setup()

    return {
        "A_x": _A_in["x"],
        "A_k_cache": _A_in["k_cache"],
        "A_v_cache": _A_in["v_cache"],
        "A_wq": _A_in["wq"],
        "A_wo": _A_in["wo"],
        "B_x": _B_in["x"],
        "B_w_gate": _B_in["w_gate"],
        "B_w_up": _B_in["w_up"],
        "B_w_down": _B_in["w_down"],
        "gate_w": _w((lambda *s: torch.randn(*s, dtype=torch.bfloat16) * 0.05)(512) * 16.0),
    }

def reference(A_x, A_k_cache, A_v_cache, A_wq, A_wo, B_x, B_w_gate, B_w_up, B_w_down, gate_w):
    def _A_ref(x, k_cache, v_cache, wq, wo):
        B, Sq, D = x.shape
        Hq, Dh = 32, 128
        Hkv = k_cache.shape[1]
        rep = Hq // Hkv
        q = (lambda x, *d: x.permute(*d))((x @ wq).reshape(B, Sq, Hq, Dh), 0, 2, 1, 3)
        k = (lambda x, n, axis: torch.repeat_interleave(x, n, dim=axis))(k_cache, rep, axis=1)
        v = (lambda x, n, axis: torch.repeat_interleave(x, n, dim=axis))(v_cache, rep, axis=1)
        scores = torch.einsum("bhqd,bhkd->bhqk", q, k) * (Dh ** -0.5)
        p = _softmax(scores, axis=-1)
        o = torch.einsum("bhqk,bhkd->bhqd", p, v)
        return (lambda x, *d: x.permute(*d))(o, 0, 2, 1, 3).reshape(B, Sq, Hq * Dh) @ wo

    def _B_ref(x, w_gate, w_up, w_down):
        g = _silu(x @ w_gate)
        u = x @ w_up
        return (g * u) @ w_down

    x = A_x
    g = _sigmoid((x * gate_w).sum(-1, keepdims=True))
    a = _A_ref(x, A_k_cache, A_v_cache, A_wq, A_wo)
    b = _B_ref(x, B_w_gate, B_w_up, B_w_down)
    return g * a + (1 - g) * b
```

```asm
; @launch grid=(256,1,1) block=(768,1,1) lds=27136
.amdgcn_target "amdgcn-amd-amdhsa--gfx950"
.text
.globl gated_mix__gqa_block_cached__swiglu_ffn__decode_kernel
.p2align 8
.type gated_mix__gqa_block_cached__swiglu_ffn__decode_kernel,@function
gated_mix__gqa_block_cached__swiglu_ffn__decode_kernel:
  s_cmp_ge_u32 s2, 256
  s_cbranch_scc1 L_END
  s_load_dwordx16 s[8:23], s[0:1], 0
  s_load_dwordx8 s[24:31], s[0:1], 64
  s_load_dwordx2 s[32:33], s[0:1], 96
  v_lshrrev_b32 v1, 6, v0
  v_and_b32 v0, 63, v0
  v_mov_b32 v2, 0
  v_readfirstlane_b32 s3, v1
  v_lshlrev_b32 v3, 2, v0
  ds_write_b32 v3, v2
  s_and_b32 s34, s2, 7
  s_lshr_b32 s37, s2, 3
  s_lshr_b32 s35, s37, 3
  s_and_b32 s36, s37, 7
  s_lshl_b32 s38, s34, 3
  s_add_u32 s38, s38, s36
  s_mov_b32 s74, 0x05040100
  s_mov_b32 s75, 0x07060302
  s_mov_b32 s92, 0x3fb8aa3b
  s_cmp_ge_u32 s3, 4
  s_cbranch_scc1 L_KV
L_AUX:
  s_setprio 3
  s_mov_b32 s46, 0x1000
  s_mov_b32 s47, 0x20000
  s_mov_b32 s43, 0x20000
  v_and_b32 v3, 15, v0
  v_lshlrev_b32 v3, 4, v3
  v_lshrrev_b32 v4, 4, v0
  s_cmp_lt_u32 s37, 16
  s_cbranch_scc0 L_P0_FFN
  s_mov_b32 s42, 0x400000
  s_mov_b32 s58, 0
  s_mov_b32 s86, 8192
  s_and_b32 s85, s37, 3
  s_lshl_b32 s90, s34, 2
  s_add_u32 s85, s85, s90
  s_lshr_b32 s89, s37, 2
  s_lshl_b32 s88, s85, 2
  s_add_u32 s88, s88, s89
  s_lshl_b32 s87, s85, 8
  s_branch L_P0_GO
L_P0_FFN:
  s_sub_u32 s85, s37, 16
  s_lshl_b32 s85, s85, 3
  s_add_u32 s85, s85, s34
  s_cmp_ge_u32 s85, 112
  s_cbranch_scc1 L_P0_SKIP
  s_add_u32 s88, s85, 128
  s_mov_b32 s86, 3584
  s_cmp_ge_u32 s85, 56
  s_mov_b32 s42, 0x1c0000
  s_cselect_b32 s58, 2, 1
  s_cselect_b32 s90, 56, 0
  s_sub_u32 s85, s85, s90
  s_and_b32 s89, s85, 3
  s_lshr_b32 s85, s85, 2
  s_lshl_b32 s87, s85, 8
L_P0_GO:
  s_lshl_b32 s89, s89, 7
  s_lshl_b32 s85, s3, 5
  s_add_u32 s89, s89, s85
  s_mul_i32 s85, s89, s86
  s_add_u32 s87, s87, s85
  s_lshl_b32 s89, s89, 1
  v_bfe_u32 v6, v0, 2, 2
  v_lshlrev_b32 v6, 10, v6
  v_and_b32 v7, 0x30, v0
  v_add_u32 v6, v6, v7
  v_lshlrev_b32 v7, 3, v4
  v_mad_u32_u24 v5, v7, s86, v3
  s_waitcnt lgkmcnt(0)
  s_mov_b64 s[44:45], s[8:9]
  s_cmp_eq_u32 s58, 1
  s_cselect_b64 s[40:41], s[20:21], s[14:15]
  s_cmp_eq_u32 s58, 2
  s_cselect_b64 s[40:41], s[22:23], s[40:41]
  buffer_load_dwordx4 v[8:11], v6, s[44:47], s89 offen
  buffer_load_dwordx4 v[40:43], v5, s[40:43], s87 offen nt
  s_add_u32 s87, s87, s86
  buffer_load_dwordx4 v[44:47], v5, s[40:43], s87 offen nt
  s_add_u32 s87, s87, s86
  buffer_load_dwordx4 v[48:51], v5, s[40:43], s87 offen nt
  s_add_u32 s87, s87, s86
  buffer_load_dwordx4 v[52:55], v5, s[40:43], s87 offen nt
  s_add_u32 s87, s87, s86
  buffer_load_dwordx4 v[56:59], v5, s[40:43], s87 offen nt
  s_add_u32 s87, s87, s86
  buffer_load_dwordx4 v[60:63], v5, s[40:43], s87 offen nt
  s_add_u32 s87, s87, s86
  buffer_load_dwordx4 v[64:67], v5, s[40:43], s87 offen nt
  s_add_u32 s87, s87, s86
  buffer_load_dwordx4 v[68:71], v5, s[40:43], s87 offen nt
  s_load_dword s73, s[32:33], 0
  s_barrier
  s_mov_b32 s48, s32
  s_and_b32 s49, s33, 0xffff
  s_mov_b32 s50, 0x400000
  s_mov_b32 s51, 0x20000
  v_mov_b32 v1, 0
  v_mov_b32 v38, 1
  s_mov_b32 s91, 0xff
  s_mov_b32 s76, 0x11111111
  s_mov_b32 s77, 0x11111111
  s_mov_b32 s78, 0x22222222
  s_mov_b32 s79, 0x22222222
  s_mov_b32 s80, 0x44444444
  s_mov_b32 s81, 0x44444444
  s_mov_b32 s82, 0x88888888
  s_mov_b32 s83, 0x88888888
  s_waitcnt vmcnt(8)
  v_cndmask_b32 v104, 0, v8, s[76:77]
  v_cndmask_b32 v105, 0, v9, s[76:77]
  v_cndmask_b32 v106, 0, v10, s[76:77]
  v_cndmask_b32 v107, 0, v11, s[76:77]
  v_cndmask_b32 v108, 0, v8, s[78:79]
  v_cndmask_b32 v109, 0, v9, s[78:79]
  v_cndmask_b32 v110, 0, v10, s[78:79]
  v_cndmask_b32 v111, 0, v11, s[78:79]
  v_cndmask_b32 v112, 0, v8, s[80:81]
  v_cndmask_b32 v113, 0, v9, s[80:81]
  v_cndmask_b32 v114, 0, v10, s[80:81]
  v_cndmask_b32 v115, 0, v11, s[80:81]
  v_cndmask_b32 v116, 0, v8, s[82:83]
  v_cndmask_b32 v117, 0, v9, s[82:83]
  v_cndmask_b32 v118, 0, v10, s[82:83]
  v_cndmask_b32 v119, 0, v11, s[82:83]
  s_waitcnt vmcnt(0)
  v_perm_b32 v72, v44, v40, s74
  v_perm_b32 v73, v52, v48, s74
  v_perm_b32 v74, v60, v56, s74
  v_perm_b32 v75, v68, v64, s74
  v_perm_b32 v88, v46, v42, s74
  v_perm_b32 v89, v54, v50, s74
  v_perm_b32 v90, v62, v58, s74
  v_perm_b32 v91, v70, v66, s74
  v_mfma_f32_16x16x32_bf16 v[20:23], v[104:107], v[72:75], 0
  v_perm_b32 v76, v44, v40, s75
  v_perm_b32 v77, v52, v48, s75
  v_perm_b32 v78, v60, v56, s75
  v_perm_b32 v79, v68, v64, s75
  v_mfma_f32_16x16x32_bf16 v[24:27], v[104:107], v[88:91], 0
  v_perm_b32 v92, v46, v42, s75
  v_perm_b32 v93, v54, v50, s75
  v_perm_b32 v94, v62, v58, s75
  v_perm_b32 v95, v70, v66, s75
  v_mfma_f32_16x16x32_bf16 v[20:23], v[108:111], v[76:79], v[20:23]
  v_perm_b32 v80, v45, v41, s74
  v_perm_b32 v81, v53, v49, s74
  v_perm_b32 v82, v61, v57, s74
  v_perm_b32 v83, v69, v65, s74
  v_mfma_f32_16x16x32_bf16 v[24:27], v[108:111], v[92:95], v[24:27]
  v_perm_b32 v96, v47, v43, s74
  v_perm_b32 v97, v55, v51, s74
  v_perm_b32 v98, v63, v59, s74
  v_perm_b32 v99, v71, v67, s74
  v_mfma_f32_16x16x32_bf16 v[20:23], v[112:115], v[80:83], v[20:23]
  v_perm_b32 v84, v45, v41, s75
  v_perm_b32 v85, v53, v49, s75
  v_perm_b32 v86, v61, v57, s75
  v_perm_b32 v87, v69, v65, s75
  v_mfma_f32_16x16x32_bf16 v[24:27], v[112:115], v[96:99], v[24:27]
  v_perm_b32 v100, v47, v43, s75
  v_perm_b32 v101, v55, v51, s75
  v_perm_b32 v102, v63, v59, s75
  v_perm_b32 v103, v71, v67, s75
  v_mfma_f32_16x16x32_bf16 v[20:23], v[116:119], v[84:87], v[20:23]
  s_nop 1
  v_mfma_f32_16x16x32_bf16 v[24:27], v[116:119], v[100:103], v[24:27]
  v_lshlrev_b32 v6, 9, v4
  s_lshl_b32 s85, s3, 11
  v_add3_u32 v6, v6, v3, s85
  s_nop 6
  ds_write_b128 v6, v[20:23] offset:2560
  ds_write_b128 v6, v[24:27] offset:2816
  s_mov_b64 exec, 1
  ds_add_rtn_u32 v8, v1, v38 offset:0
  s_mov_b64 exec, -1
  s_waitcnt lgkmcnt(0)
  v_readfirstlane_b32 s85, v8
  s_add_u32 s72, s73, 1
  s_and_b32 s72, s72, 0xff
  s_cmp_eq_u32 s85, 3
  s_cbranch_scc0 L_P0_DONE
  v_mov_b32 v2, s72
  v_lshlrev_b32 v6, 4, v0
  ds_read_b128 v[40:43], v6 offset:2560
  ds_read_b128 v[44:47], v6 offset:4608
  ds_read_b128 v[48:51], v6 offset:6656
  ds_read_b128 v[52:55], v6 offset:8704
  ds_read_b128 v[56:59], v6 offset:3584
  ds_read_b128 v[60:63], v6 offset:5632
  ds_read_b128 v[64:67], v6 offset:7680
  ds_read_b128 v[68:71], v6 offset:9728
  v_lshrrev_b32 v6, 5, v0
  v_lshlrev_b32 v6, 9, v6
  v_lshlrev_b32 v7, 1, v3
  v_and_b32 v8, 16, v0
  v_add3_u32 v6, v6, v7, v8
  s_lshr_b32 s85, s88, 4
  s_lshl_b32 s85, s85, 11
  s_and_b32 s88, s88, 15
  s_lshl_b32 s88, s88, 17
  s_add_u32 s85, s85, s88
  s_add_u32 s85, s85, 0x1000
  s_waitcnt lgkmcnt(0)
  v_add_f32 v40, v40, v44
  v_add_f32 v48, v48, v52
  v_add_f32 v41, v41, v45
  v_add_f32 v49, v49, v53
  v_add_f32 v42, v42, v46
  v_add_f32 v50, v50, v54
  v_add_f32 v43, v43, v47
  v_add_f32 v51, v51, v55
  v_add_f32 v40, v40, v48
  v_add_f32 v41, v41, v49
  v_add_f32 v42, v42, v50
  v_add_f32 v43, v43, v51
  v_bfi_b32 v40, s91, v2, v40
  v_bfi_b32 v41, s91, v2, v41
  v_bfi_b32 v42, s91, v2, v42
  v_bfi_b32 v43, s91, v2, v43
  buffer_store_dwordx4 v[40:43], v6, s[48:51], s85 offen offset:0
  v_add_f32 v56, v56, v60
  v_add_f32 v64, v64, v68
  v_add_f32 v57, v57, v61
  v_add_f32 v65, v65, v69
  v_add_f32 v58, v58, v62
  v_add_f32 v66, v66, v70
  v_add_f32 v59, v59, v63
  v_add_f32 v67, v67, v71
  v_add_f32 v56, v56, v64
  v_add_f32 v57, v57, v65
  v_add_f32 v58, v58, v66
  v_add_f32 v59, v59, v67
  v_bfi_b32 v56, s91, v2, v56
  v_bfi_b32 v57, s91, v2, v57
  v_bfi_b32 v58, s91, v2, v58
  v_bfi_b32 v59, s91, v2, v59
  buffer_store_dwordx4 v[56:59], v6, s[48:51], s85 offen offset:1024
  s_add_u32 s85, s85, 0x200000
  buffer_store_dwordx4 v[40:43], v6, s[48:51], s85 offen offset:0 sc1
  buffer_store_dwordx4 v[56:59], v6, s[48:51], s85 offen offset:1024 sc1
  s_branch L_P0_DONE
L_P0_SKIP:
  s_waitcnt lgkmcnt(0)
  s_load_dword s73, s[32:33], 0
  s_barrier
  s_mov_b32 s48, s32
  s_and_b32 s49, s33, 0xffff
  s_mov_b32 s50, 0x400000
  s_mov_b32 s51, 0x20000
  v_mov_b32 v1, 0
  v_mov_b32 v38, 1
  s_mov_b32 s91, 0xff
L_P0_DONE:
  s_waitcnt lgkmcnt(0)
  s_add_u32 s72, s73, 1
  s_and_b32 s72, s72, 0xff
  v_mov_b32 v2, s72
  s_cmp_eq_u32 s3, 1
  s_cbranch_scc0 L_noxcc_2
  s_getreg_b32 s85, hwreg(HW_REG_XCC_ID)
  s_lshl_b32 s85, s85, 8
  s_or_b32 s85, s85, s72
  v_mov_b32 v16, s85
  v_mov_b32 v17, s85
  v_mov_b32 v18, s85
  v_mov_b32 v19, s85
  s_lshl_b32 s86, s34, 9
  s_lshl_b32 s87, s37, 4
  s_add_u32 s86, s86, s87
  s_add_u32 s86, s86, 0x1a000
  s_mov_b64 exec, 1
  buffer_store_dwordx4 v[16:19], v1, s[48:51], s86 offen sc1
  s_mov_b64 exec, -1
  s_nop 1
L_noxcc_2:
  v_lshrrev_b32 v16, 5, v0
  v_lshlrev_b32 v16, 17, v16
  v_and_b32 v17, 31, v0
  v_lshlrev_b32 v17, 4, v17
  v_add_u32 v6, v16, v17
  s_lshl_b32 s86, s34, 11
  s_lshl_b32 s87, s3, 19
  s_add_u32 s86, s86, s87
  s_lshl_b32 s87, s35, 9
  s_add_u32 s86, s86, s87
  s_add_u32 s86, s86, 0x1000
  s_add_u32 s87, s86, 0x40000
  v_and_b32 v16, 7, v0
  v_min_u32 v16, 6, v16
  v_lshlrev_b32 v16, 2, v16
  s_mul_i32 s88, s38, 28
  v_add_u32 v16, s88, v16
  v_lshrrev_b32 v17, 7, v16
  v_and_b32 v16, 127, v16
  v_lshlrev_b32 v16, 2, v16
  v_lshrrev_b32 v18, 5, v0
  v_mul_u32_u24 v18, 14, v18
  v_add_u32 v17, v17, v18
  v_lshrrev_b32 v18, 2, v17
  v_lshlrev_b32 v18, 11, v18
  v_add_u32 v16, v16, v18
  v_and_b32 v17, 3, v17
  v_lshlrev_b32 v17, 19, v17
  v_bfe_u32 v18, v0, 3, 2
  v_lshlrev_b32 v18, 17, v18
  v_add3_u32 v7, v16, v17, v18
  s_lshl_b32 s88, s3, 9
  s_add_u32 s88, s88, 0x205000
  s_mov_b32 s84, 32768
  s_sleep 40
L_poll_3:
  buffer_load_dwordx4 v[16:19], v6, s[48:51], s86 offen sc1
  buffer_load_dwordx4 v[20:23], v6, s[48:51], s87 offen sc1
  s_waitcnt vmcnt(0)
  v_xor_b32 v16, s72, v16
  v_xor_b32 v17, s72, v17
  v_xor_b32 v18, s72, v18
  v_xor_b32 v19, s72, v19
  v_xor_b32 v20, s72, v20
  v_xor_b32 v21, s72, v21
  v_xor_b32 v22, s72, v22
  v_xor_b32 v23, s72, v23
  v_or3_b32 v28, v16, v17, v18
  v_or3_b32 v28, v28, v19, v20
  v_or3_b32 v28, v28, v21, v22
  v_or_b32 v28, v28, v23
  v_and_b32 v28, 0xff, v28
  v_cmp_ne_u32 vcc, 0, v28
  s_cbranch_vccz L_polld_4
  s_mov_b64 exec, vcc
  s_sleep 8
  s_sub_u32 s84, s84, 1
  s_and_b32 s85, s84, 63
  s_cmp_le_u32 s85, 1
  s_cselect_b32 s85, 0x200000, 0
  s_xor_b32 s86, s86, s85
  s_xor_b32 s87, s87, s85
  s_cmp_lg_u32 s84, 0
  s_cbranch_scc1 L_poll_3
L_polld_4:
  s_mov_b64 exec, -1
  v_add_f32 v16, v16, v20
  v_add_f32 v17, v17, v21
  v_add_f32 v18, v18, v22
  v_add_f32 v19, v19, v23
  v_mov_b32 v20, v16
  v_mov_b32 v21, v17
  v_mov_b32 v22, v18
  v_mov_b32 v23, v19
  s_nop 0
  v_permlane32_swap_b32 v16, v20
  v_permlane32_swap_b32 v17, v21
  v_permlane32_swap_b32 v18, v22
  v_permlane32_swap_b32 v19, v23
  s_nop 0
  v_add_f32 v16, v16, v20
  v_add_f32 v17, v17, v21
  v_add_f32 v18, v18, v22
  v_add_f32 v19, v19, v23
  v_cvt_pk_bf16_f32 v16, v16, v17
  v_cvt_pk_bf16_f32 v17, v18, v19
  v_and_b32 v28, 31, v0
  v_lshlrev_b32 v28, 3, v28
  s_mul_i32 s85, s3, 272
  v_add_u32 v28, s85, v28
  s_mov_b32 exec_hi, 0
  ds_write_b64 v28, v[16:17] offset:512
  s_mov_b64 exec, 1
  ds_add_u32 v1, v38 offset:8
  s_mov_b64 exec, -1
  v_lshlrev_b32 v5, 13, v4
  s_lshl_b32 s85, s35, 8
  v_add3_u32 v5, v5, v3, s85
  v_and_b32 v44, 31, v0
  v_lshlrev_b32 v44, 4, v44
  s_lshl_b32 s60, s34, 9
  s_add_u32 s60, s60, 0x1a000
  buffer_load_dwordx4 v[40:43], v44, s[48:51], s60 offen sc1
  s_mov_b32 s84, 32768
L_poll_6:
  buffer_load_dwordx4 v[24:27], v7, s[48:51], s88 offen sc1
  s_waitcnt vmcnt(0)
  v_xor_b32 v24, s72, v24
  v_xor_b32 v25, s72, v25
  v_xor_b32 v26, s72, v26
  v_xor_b32 v27, s72, v27
  v_or3_b32 v28, v24, v25, v26
  v_or_b32 v28, v28, v27
  v_and_b32 v28, 0xff, v28
  v_cmp_ne_u32 vcc, 0, v28
  s_cbranch_vccz L_polld_7
  s_mov_b64 exec, vcc
  s_sleep 8
  s_sub_u32 s84, s84, 1
  s_cmp_lg_u32 s84, 0
  s_cbranch_scc1 L_poll_6
L_polld_7:
  s_mov_b64 exec, -1
  s_mov_b32 s84, 32768
  s_branch L_pollw_11
L_poll_9:
  buffer_load_dwordx4 v[40:43], v44, s[48:51], s60 offen sc1
L_pollw_11:
  s_waitcnt vmcnt(0)
  v_xor_b32 v40, s72, v40
  v_xor_b32 v41, s72, v41
  v_xor_b32 v42, s72, v42
  v_xor_b32 v43, s72, v43
  v_or3_b32 v28, v40, v41, v42
  v_or_b32 v28, v28, v43
  v_and_b32 v28, 0xff, v28
  v_cmp_ne_u32 vcc, 0, v28
  s_cbranch_vccz L_polld_10
  s_sleep 8
  s_sub_u32 s84, s84, 1
  s_cmp_lg_u32 s84, 0
  s_cbranch_scc1 L_poll_9
L_polld_10:
  v_readfirstlane_b32 s85, v40
  s_nop 1
  v_cmp_ne_u32 vcc, s85, v40
  s_nop 0
  s_cmp_eq_u64 vcc, 0
  s_cselect_b32 s60, 0, 0x200000
  s_cselect_b32 s85, 1, 2
  v_mov_b32 v40, s85
  s_mov_b64 exec, 1
  ds_write_b32 v1, v40 offset:44
  s_mov_b64 exec, -1
  v_add_f32_dpp v24, v24, v24 row_ror:8 row_mask:0xf bank_mask:0xf
  v_add_f32_dpp v25, v25, v25 row_ror:8 row_mask:0xf bank_mask:0xf
  v_add_f32_dpp v26, v26, v26 row_ror:8 row_mask:0xf bank_mask:0xf
  v_add_f32_dpp v27, v27, v27 row_ror:8 row_mask:0xf bank_mask:0xf
  v_mov_b32 v16, v24
  v_mov_b32 v17, v25
  v_mov_b32 v18, v26
  v_mov_b32 v19, v27
  s_nop 0
  v_permlane16_swap_b32 v24, v16
  v_permlane16_swap_b32 v25, v17
  v_permlane16_swap_b32 v26, v18
  v_permlane16_swap_b32 v27, v19
  s_nop 0
  v_add_f32 v24, v24, v16
  v_add_f32 v25, v25, v17
  v_add_f32 v26, v26, v18
  v_add_f32 v27, v27, v19
  v_cvt_pk_bf16_f32 v16, v24, v25
  v_lshlrev_b32 v24, 16, v16
  v_and_b32 v25, 0xffff0000, v16
  v_cvt_pk_bf16_f32 v17, v26, v27
  v_lshlrev_b32 v26, 16, v17
  v_and_b32 v27, 0xffff0000, v17
  v_mul_f32 v16, s92, v24
  v_mul_f32 v17, s92, v25
  v_mul_f32 v18, s92, v26
  v_mul_f32 v19, s92, v27
  v_exp_f32 v16, -v16
  v_exp_f32 v17, -v17
  v_exp_f32 v18, -v18
  v_exp_f32 v19, -v19
  s_nop 0
  v_add_f32 v16, 1.0, v16
  v_add_f32 v17, 1.0, v17
  v_add_f32 v18, 1.0, v18
  v_add_f32 v19, 1.0, v19
  v_rcp_f32 v16, v16
  v_rcp_f32 v17, v17
  v_rcp_f32 v18, v18
  v_rcp_f32 v19, v19
  s_nop 0
  v_mul_f32 v16, v16, v24
  v_mul_f32 v17, v17, v25
  v_mul_f32 v18, v18, v26
  v_mul_f32 v19, v19, v27
  v_cvt_pk_bf16_f32 v20, v16, v17
  v_lshlrev_b32 v16, 16, v20
  v_and_b32 v17, 0xffff0000, v20
  v_cvt_pk_bf16_f32 v21, v18, v19
  v_lshlrev_b32 v18, 16, v21
  v_and_b32 v19, 0xffff0000, v21
  v_mov_b32 v20, v24
  v_mov_b32 v21, v25
  v_mov_b32 v22, v26
  v_mov_b32 v23, v27
  s_nop 0
  v_permlane32_swap_b32 v24, v20
  v_permlane32_swap_b32 v25, v21
  v_permlane32_swap_b32 v26, v22
  v_permlane32_swap_b32 v27, v23
  s_nop 0
  v_mul_f32 v16, v16, v20
  v_mul_f32 v17, v17, v21
  v_mul_f32 v18, v18, v22
  v_mul_f32 v19, v19, v23
  v_cvt_pk_bf16_f32 v16, v16, v17
  v_cvt_pk_bf16_f32 v17, v18, v19
  v_cmp_eq_u32 vcc, 7, v0
  v_lshlrev_b32 v18, 3, v0
  s_lshl_b32 s85, s3, 6
  v_cndmask_b32 v16, v16, v1, vcc
  v_cndmask_b32 v17, v17, v1, vcc
  v_add_u32 v18, s85, v18
  s_mov_b64 exec, 0xff
  ds_write_b64 v18, v[16:17] offset:1664
  s_mov_b64 exec, 1
  ds_add_u32 v1, v38 offset:24
  s_mov_b64 exec, -1
  v_lshrrev_b32 v16, 5, v0
  v_lshlrev_b32 v16, 13, v16
  v_and_b32 v17, 31, v0
  v_lshlrev_b32 v17, 4, v17
  s_lshl_b32 s85, s3, 9
  v_add3_u32 v32, v16, v17, s85
  v_lshlrev_b32 v16, 1, v3
  v_and_b32 v17, 16, v0
  v_add_u32 v33, v16, v17
  s_lshl_b32 s90, s35, 3
  s_add_u32 s90, s90, s34
  s_lshl_b32 s85, s3, 2
  s_and_b32 s88, s90, 3
  s_add_u32 s85, s85, s88
  s_lshl_b32 s85, s85, 17
  s_lshr_b32 s88, s90, 2
  s_lshl_b32 s88, s88, 3
  s_add_u32 s88, s88, s36
  s_lshl_b32 s93, s88, 9
  s_add_u32 s93, s93, s85
  s_add_u32 s93, s93, 0xa000
  s_lshl_b32 s89, s88, 4
  s_add_u32 s89, s89, s85
  s_add_u32 s89, s89, 0x9000
  s_lshl_b32 s39, s35, 2
  s_and_b32 s88, s38, 3
  s_add_u32 s39, s39, s88
  s_lshl_b32 s39, s39, 17
  s_lshr_b32 s88, s38, 2
  s_lshl_b32 s88, s88, 11
  s_add_u32 s39, s39, s88
  s_add_u32 s39, s39, 0x12000
  s_mov_b32 s84, 1048576
L_spin_12:
  ds_read_b32 v16, v1 offset:28
  s_waitcnt lgkmcnt(0)
  v_readfirstlane_b32 s85, v16
  s_cmp_ge_u32 s85, 8
  s_cbranch_scc1 L_spind_13
  s_sleep 1
  s_sub_u32 s84, s84, 1
  s_cmp_lg_u32 s84, 0
  s_cbranch_scc1 L_spin_12
L_spind_13:
  s_mov_b32 s84, 1048576
L_spin_14:
  ds_read_b32 v16, v1 offset:16
  s_waitcnt lgkmcnt(0)
  v_readfirstlane_b32 s85, v16
  s_cmp_ge_u32 s85, 8
  s_cbranch_scc1 L_spind_15
  s_sleep 1
  s_sub_u32 s84, s84, 1
  s_cmp_lg_u32 s84, 0
  s_cbranch_scc1 L_spin_14
L_spind_15:
  v_and_b32 v16, 7, v0
  v_lshlrev_b32 v16, 2, v16
  s_lshl_b32 s85, s3, 5
  v_add_u32 v16, s85, v16
  ds_read_b32 v17, v16 offset:256
  ds_read_b32 v18, v16 offset:384
  s_waitcnt lgkmcnt(0)
  v_mov_b32 v19, v17
  s_nop 1
  v_max_f32_dpp v19, v19, v19 row_ror:1 row_mask:0xf bank_mask:0xf
  s_nop 1
  v_max_f32_dpp v19, v19, v19 row_ror:2 row_mask:0xf bank_mask:0xf
  s_nop 1
  v_max_f32_dpp v19, v19, v19 row_ror:4 row_mask:0xf bank_mask:0xf
  v_sub_f32 v17, v17, v19
  v_mul_f32 v17, s92, v17
  v_exp_f32 v17, v17
  s_nop 0
  v_mul_f32 v18, v17, v18
  s_nop 1
  v_add_f32_dpp v18, v18, v18 row_ror:1 row_mask:0xf bank_mask:0xf
  s_nop 1
  v_add_f32_dpp v18, v18, v18 row_ror:2 row_mask:0xf bank_mask:0xf
  s_nop 1
  v_add_f32_dpp v18, v18, v18 row_ror:4 row_mask:0xf bank_mask:0xf
  v_bfi_b32 v16, s91, v2, v19
  v_bfi_b32 v17, s91, v2, v18
  v_bfi_b32 v18, s91, v2, v19
  v_mov_b32 v19, v17
  s_mov_b64 exec, 1
  s_cmp_eq_u32 s60, 0
  s_cbranch_scc0 L_xs_16
  buffer_store_dwordx4 v[16:19], v1, s[48:51], s89 offen
  s_branch L_xsd_17
L_xs_16:
  s_add_u32 s89, s89, 0x200000
  buffer_store_dwordx4 v[16:19], v1, s[48:51], s89 offen sc1
L_xsd_17:
  s_mov_b64 exec, -1
  s_cmp_eq_u32 s3, 0
  s_cbranch_scc0 L_NOW1
  s_mov_b32 s52, s16
  s_and_b32 s53, s17, 0xffff
  s_mov_b32 s54, 0x400000
  s_mov_b32 s55, 0x20000
  s_lshl_b32 s87, s38, 16
  s_mov_b32 s84, 1048576
L_spin_18:
  ds_read_b32 v16, v1 offset:28
  s_waitcnt lgkmcnt(0)
  v_readfirstlane_b32 s85, v16
  s_cmp_ge_u32 s85, 8
  s_cbranch_scc1 L_spind_19
  s_sleep 1
  s_sub_u32 s84, s84, 1
  s_cmp_lg_u32 s84, 0
  s_cbranch_scc1 L_spin_18
L_spind_19:
  s_mov_b32 s56, s24
  s_and_b32 s57, s25, 0xffff
  s_mov_b32 s58, 0x1c0000
  s_mov_b32 s59, 0x20000
  v_mov_b32 v29, 0x40000000
  v_cmp_eq_u32 vcc, 3, v4
  s_mul_i32 s85, s38, 28672
  s_add_u32 s86, s85, 4096
  v_cndmask_b32 v28, v5, v29, vcc
  buffer_load_dwordx4 v[136:139], v5, s[56:59], s85 offen offset:0 nt
  buffer_load_dwordx4 v[140:143], v5, s[56:59], s85 offen offset:1024 nt
  buffer_load_dwordx4 v[144:147], v5, s[56:59], s85 offen offset:2048 nt
  buffer_load_dwordx4 v[148:151], v5, s[56:59], s85 offen offset:3072 nt
  buffer_load_dwordx4 v[152:155], v28, s[56:59], s86 offen offset:0 nt
  buffer_load_dwordx4 v[156:159], v28, s[56:59], s86 offen offset:1024 nt
  buffer_load_dwordx4 v[160:163], v28, s[56:59], s86 offen offset:2048 nt
  buffer_load_dwordx4 v[164:167], v28, s[56:59], s86 offen offset:3072 nt
  s_add_u32 s86, s87, 0
  buffer_load_dwordx4 v[40:43], v5, s[52:55], s86 offen offset:0 nt
  buffer_load_dwordx4 v[44:47], v5, s[52:55], s86 offen offset:1024 nt
  buffer_load_dwordx4 v[48:51], v5, s[52:55], s86 offen offset:2048 nt
  buffer_load_dwordx4 v[52:55], v5, s[52:55], s86 offen offset:3072 nt
  s_add_u32 s86, s87, 4096
  buffer_load_dwordx4 v[56:59], v5, s[52:55], s86 offen offset:0 nt
  buffer_load_dwordx4 v[60:63], v5, s[52:55], s86 offen offset:1024 nt
  buffer_load_dwordx4 v[64:67], v5, s[52:55], s86 offen offset:2048 nt
  buffer_load_dwordx4 v[68:71], v5, s[52:55], s86 offen offset:3072 nt
  s_add_u32 s86, s87, 32768
  buffer_load_dwordx4 v[104:107], v5, s[52:55], s86 offen offset:0 nt
  buffer_load_dwordx4 v[108:111], v5, s[52:55], s86 offen offset:1024 nt
  buffer_load_dwordx4 v[112:115], v5, s[52:55], s86 offen offset:2048 nt
  buffer_load_dwordx4 v[116:119], v5, s[52:55], s86 offen offset:3072 nt
  s_add_u32 s86, s87, 36864
  buffer_load_dwordx4 v[120:123], v5, s[52:55], s86 offen offset:0 nt
  buffer_load_dwordx4 v[124:127], v5, s[52:55], s86 offen offset:1024 nt
  buffer_load_dwordx4 v[128:131], v5, s[52:55], s86 offen offset:2048 nt
  buffer_load_dwordx4 v[132:135], v5, s[52:55], s86 offen offset:3072 nt
L_NOW1:
  s_mov_b32 s84, 1048576
L_spin_20:
  ds_read_b32 v16, v1 offset:20
  s_waitcnt lgkmcnt(0)
  v_readfirstlane_b32 s85, v16
  s_cmp_ge_u32 s85, 8
  s_cbranch_scc1 L_spind_21
  s_sub_u32 s84, s84, 1
  s_cmp_lg_u32 s84, 0
  s_cbranch_scc1 L_spin_20
L_spind_21:
  ds_read_b128 v[16:19], v32 offset:10752
  ds_read_b128 v[20:23], v32 offset:12800
  ds_read_b128 v[24:27], v32 offset:14848
  ds_read_b128 v[28:31], v32 offset:16896
  s_waitcnt lgkmcnt(2)
  v_add_f32 v16, v16, v20
  v_add_f32 v17, v17, v21
  v_add_f32 v18, v18, v22
  v_add_f32 v19, v19, v23
  s_waitcnt lgkmcnt(0)
  v_add_f32 v24, v24, v28
  v_add_f32 v25, v25, v29
  v_add_f32 v26, v26, v30
  v_add_f32 v27, v27, v31
  v_add_f32 v16, v16, v24
  v_add_f32 v17, v17, v25
  v_add_f32 v18, v18, v26
  v_add_f32 v19, v19, v27
  v_mov_b32 v20, v16
  v_mov_b32 v21, v17
  v_mov_b32 v22, v18
  v_mov_b32 v23, v19
  s_nop 0
  v_permlane32_swap_b32 v16, v20
  v_permlane32_swap_b32 v17, v21
  v_permlane32_swap_b32 v18, v22
  v_permlane32_swap_b32 v19, v23
  s_nop 0
  v_add_f32 v16, v16, v20
  v_add_f32 v17, v17, v21
  v_add_f32 v18, v18, v22
  v_add_f32 v19, v19, v23
  v_bfi_b32 v16, s91, v2, v16
  v_bfi_b32 v17, s91, v2, v17
  v_bfi_b32 v18, s91, v2, v18
  v_bfi_b32 v19, s91, v2, v19
  s_mov_b32 exec_hi, 0
  s_cmp_eq_u32 s60, 0
  s_cbranch_scc0 L_xs_22
  buffer_store_dwordx4 v[16:19], v33, s[48:51], s93 offen
  s_branch L_xsd_23
L_xs_22:
  s_add_u32 s93, s93, 0x200000
  buffer_store_dwordx4 v[16:19], v33, s[48:51], s93 offen sc1
L_xsd_23:
  s_mov_b64 exec, -1
  s_cmp_eq_u32 s3, 0
  s_cbranch_scc0 L_NOW3
  s_waitcnt vmcnt(17)
  v_perm_b32 v72, v140, v136, s74
  v_perm_b32 v73, v148, v144, s74
  v_perm_b32 v74, v156, v152, s74
  v_perm_b32 v75, v164, v160, s74
  v_perm_b32 v76, v140, v136, s75
  v_perm_b32 v77, v148, v144, s75
  v_perm_b32 v78, v156, v152, s75
  v_perm_b32 v79, v164, v160, s75
  v_perm_b32 v80, v141, v137, s74
  v_perm_b32 v81, v149, v145, s74
  v_perm_b32 v82, v157, v153, s74
  v_perm_b32 v83, v165, v161, s74
  v_perm_b32 v84, v141, v137, s75
  v_perm_b32 v85, v149, v145, s75
  v_perm_b32 v86, v157, v153, s75
  v_perm_b32 v87, v165, v161, s75
  v_perm_b32 v88, v142, v138, s74
  v_perm_b32 v89, v150, v146, s74
  v_perm_b32 v90, v158, v154, s74
  v_perm_b32 v91, v166, v162, s74
  v_perm_b32 v92, v142, v138, s75
  v_perm_b32 v93, v150, v146, s75
  v_perm_b32 v94, v158, v154, s75
  v_perm_b32 v95, v166, v162, s75
  v_perm_b32 v96, v143, v139, s74
  v_perm_b32 v97, v151, v147, s74
  v_perm_b32 v98, v159, v155, s74
  v_perm_b32 v99, v167, v163, s74
  v_perm_b32 v100, v143, v139, s75
  v_perm_b32 v101, v151, v147, s75
  v_perm_b32 v102, v159, v155, s75
  v_perm_b32 v103, v167, v163, s75
  s_mov_b32 s84, 1048576
L_spin_24:
  ds_read_b32 v16, v1 offset:24
  s_waitcnt lgkmcnt(0)
  v_readfirstlane_b32 s85, v16
  s_cmp_ge_u32 s85, 4
  s_cbranch_scc1 L_spind_25
  s_sleep 1
  s_sub_u32 s84, s84, 1
  s_cmp_lg_u32 s84, 0
  s_cbranch_scc1 L_spin_24
L_spind_25:
  v_bfe_u32 v16, v0, 2, 2
  v_lshlrev_b32 v17, 6, v16
  v_lshlrev_b32 v18, 4, v4
  v_add_u32 v17, v17, v18
  ds_read_b128 v[20:23], v17 offset:1664
  s_waitcnt lgkmcnt(0)
  v_mfma_f32_16x16x32_bf16 v[136:139], v[20:23], v[72:75], 0
  v_mfma_f32_16x16x32_bf16 v[140:143], v[20:23], v[76:79], 0
  v_mfma_f32_16x16x32_bf16 v[144:147], v[20:23], v[80:83], 0
  v_mfma_f32_16x16x32_bf16 v[148:151], v[20:23], v[84:87], 0
  v_mfma_f32_16x16x32_bf16 v[152:155], v[20:23], v[88:91], 0
  v_mfma_f32_16x16x32_bf16 v[156:159], v[20:23], v[92:95], 0
  v_mfma_f32_16x16x32_bf16 v[160:163], v[20:23], v[96:99], 0
  v_mfma_f32_16x16x32_bf16 v[164:167], v[20:23], v[100:103], 0
  s_nop 7
  v_mov_b32 v8, v136
  v_mov_b32 v9, v140
  v_mov_b32 v10, v144
  v_mov_b32 v11, v148
  v_mov_b32 v12, v152
  v_mov_b32 v13, v156
  v_mov_b32 v14, v160
  v_mov_b32 v15, v164
  s_waitcnt vmcnt(9)
  v_perm_b32 v136, v44, v40, s74
  v_perm_b32 v137, v52, v48, s74
  v_perm_b32 v138, v60, v56, s74
  v_perm_b32 v139, v68, v64, s74
  v_perm_b32 v140, v44, v40, s75
  v_perm_b32 v141, v52, v48, s75
  v_perm_b32 v142, v60, v56, s75
  v_perm_b32 v143, v68, v64, s75
  v_perm_b32 v144, v45, v41, s74
  v_perm_b32 v145, v53, v49, s74
  v_perm_b32 v146, v61, v57, s74
  v_perm_b32 v147, v69, v65, s74
  v_perm_b32 v148, v45, v41, s75
  v_perm_b32 v149, v53, v49, s75
  v_perm_b32 v150, v61, v57, s75
  v_perm_b32 v151, v69, v65, s75
  v_perm_b32 v152, v46, v42, s74
  v_perm_b32 v153, v54, v50, s74
  v_perm_b32 v154, v62, v58, s74
  v_perm_b32 v155, v70, v66, s74
  v_perm_b32 v156, v46, v42, s75
  v_perm_b32 v157, v54, v50, s75
  v_perm_b32 v158, v62, v58, s75
  v_perm_b32 v159, v70, v66, s75
  v_perm_b32 v160, v47, v43, s74
  v_perm_b32 v161, v55, v51, s74
  v_perm_b32 v162, v63, v59, s74
  v_perm_b32 v163, v71, v67, s74
  v_perm_b32 v164, v47, v43, s75
  v_perm_b32 v165, v55, v51, s75
  v_perm_b32 v166, v63, v59, s75
  v_perm_b32 v167, v71, v67, s75
  s_waitcnt vmcnt(1)
  v_perm_b32 v40, v108, v104, s74
  v_perm_b32 v41, v116, v112, s74
  v_perm_b32 v42, v124, v120, s74
  v_perm_b32 v43, v132, v128, s74
  v_perm_b32 v44, v108, v104, s75
  v_perm_b32 v45, v116, v112, s75
  v_perm_b32 v46, v124, v120, s75
  v_perm_b32 v47, v132, v128, s75
  v_perm_b32 v48, v109, v105, s74
  v_perm_b32 v49, v117, v113, s74
  v_perm_b32 v50, v125, v121, s74
  v_perm_b32 v51, v133, v129, s74
  v_perm_b32 v52, v109, v105, s75
  v_perm_b32 v53, v117, v113, s75
  v_perm_b32 v54, v125, v121, s75
  v_perm_b32 v55, v133, v129, s75
  v_perm_b32 v56, v110, v106, s74
  v_perm_b32 v57, v118, v114, s74
  v_perm_b32 v58, v126, v122, s74
  v_perm_b32 v59, v134, v130, s74
  v_perm_b32 v60, v110, v106, s75
  v_perm_b32 v61, v118, v114, s75
  v_perm_b32 v62, v126, v122, s75
  v_perm_b32 v63, v134, v130, s75
  v_perm_b32 v64, v111, v107, s74
  v_perm_b32 v65, v119, v115, s74
  v_perm_b32 v66, v127, v123, s74
  v_perm_b32 v67, v135, v131, s74
  v_perm_b32 v68, v111, v107, s75
  v_perm_b32 v69, v119, v115, s75
  v_perm_b32 v70, v127, v123, s75
  v_perm_b32 v71, v135, v131, s75
  v_bfe_u32 v16, v0, 2, 2
  v_lshlrev_b32 v16, 7, v16
  v_lshlrev_b32 v17, 4, v4
  v_add_u32 v16, v16, v17
  v_lshlrev_b32 v17, 9, v4
  v_add_u32 v33, v17, v3
  v_lshlrev_b32 v18, 3, v4
  s_mov_b32 s84, 1048576
L_spin_26:
  ds_read_b32 v19, v1 offset:36
  s_waitcnt lgkmcnt(0)
  v_readfirstlane_b32 s85, v19
  s_cmp_ge_u32 s85, 4
  s_cbranch_scc1 L_spind_27
  s_sub_u32 s84, s84, 1
  s_cmp_lg_u32 s84, 0
  s_cbranch_scc1 L_spin_26
L_spind_27:
  ds_read_b64 v[36:37], v18 offset:1920
  s_waitcnt lgkmcnt(0)
  v_mul_f32 v8, v37, v8
  v_mul_f32 v9, v37, v9
  v_mul_f32 v10, v37, v10
  v_mul_f32 v11, v37, v11
  v_mul_f32 v12, v37, v12
  v_mul_f32 v13, v37, v13
  v_mul_f32 v14, v37, v14
  v_mul_f32 v15, v37, v15
  s_mov_b32 s84, 1048576
L_spin_28:
  ds_read_b32 v18, v1 offset:32
  s_waitcnt lgkmcnt(0)
  v_readfirstlane_b32 s85, v18
  s_cmp_ge_u32 s85, 4
  s_cbranch_scc1 L_spind_29
  s_sub_u32 s84, s84, 1
  s_cmp_lg_u32 s84, 0
  s_cbranch_scc1 L_spin_28
L_spind_29:
  ds_read_b128 v[24:27], v16 offset:1952
  ds_read_b128 v[28:31], v16 offset:2016
  s_waitcnt lgkmcnt(1)
  v_mfma_f32_16x16x32_bf16 v[72:75], v[24:27], v[136:139], 0
  v_mfma_f32_16x16x32_bf16 v[76:79], v[24:27], v[140:143], 0
  s_waitcnt lgkmcnt(0)
  v_mfma_f32_16x16x32_bf16 v[72:75], v[28:31], v[40:43], v[72:75]
  v_mfma_f32_16x16x32_bf16 v[76:79], v[28:31], v[44:47], v[76:79]
  v_mfma_f32_16x16x32_bf16 v[80:83], v[24:27], v[144:147], 0
  v_mfma_f32_16x16x32_bf16 v[84:87], v[24:27], v[148:151], 0
  v_mfma_f32_16x16x32_bf16 v[80:83], v[28:31], v[48:51], v[80:83]
  v_mfma_f32_16x16x32_bf16 v[84:87], v[28:31], v[52:55], v[84:87]
  v_mfma_f32_16x16x32_bf16 v[88:91], v[24:27], v[152:155], 0
  v_mfma_f32_16x16x32_bf16 v[92:95], v[24:27], v[156:159], 0
  v_mfma_f32_16x16x32_bf16 v[88:91], v[28:31], v[56:59], v[88:91]
  v_fma_f32 v16, v36, v72, v8
  v_bfi_b32 v16, s91, v2, v16
  v_mfma_f32_16x16x32_bf16 v[92:95], v[28:31], v[60:63], v[92:95]
  v_fma_f32 v17, v36, v76, v9
  v_bfi_b32 v17, s91, v2, v17
  v_mfma_f32_16x16x32_bf16 v[96:99], v[24:27], v[160:163], 0
  v_fma_f32 v18, v36, v80, v10
  v_bfi_b32 v18, s91, v2, v18
  v_mfma_f32_16x16x32_bf16 v[100:103], v[24:27], v[164:167], 0
  v_fma_f32 v19, v36, v84, v11
  v_bfi_b32 v19, s91, v2, v19
  v_mfma_f32_16x16x32_bf16 v[96:99], v[28:31], v[64:67], v[96:99]
  buffer_store_dwordx4 v[16:19], v33, s[48:51], s39 offen sc1
  v_mfma_f32_16x16x32_bf16 v[100:103], v[28:31], v[68:71], v[100:103]
  v_fma_f32 v20, v36, v88, v12
  v_bfi_b32 v20, s91, v2, v20
  v_fma_f32 v21, v36, v92, v13
  v_bfi_b32 v21, s91, v2, v21
  s_nop 1
  v_fma_f32 v22, v36, v96, v14
  v_bfi_b32 v22, s91, v2, v22
  v_fma_f32 v23, v36, v100, v15
  v_bfi_b32 v23, s91, v2, v23
  buffer_store_dwordx4 v[20:23], v33, s[48:51], s39 offen offset:256 sc1
  s_branch L_AUX_END
L_NOW3:
  s_cmp_eq_u32 s3, 2
  s_cbranch_scc0 L_NOBUMP
  s_cmp_eq_u32 s2, 0
  s_cbranch_scc0 L_AUX_END
  v_and_b32 v6, 3, v0
  v_lshlrev_b32 v6, 17, v6
  v_lshrrev_b32 v7, 2, v0
  v_lshlrev_b32 v7, 11, v7
  v_add_u32 v6, v6, v7
  s_mov_b32 s52, 0x12000
  s_mov_b32 s53, 0x92000
  s_mov_b32 s54, 0x112000
  s_mov_b32 s55, 0x192000
  s_mov_b32 s84, 1048576
L_spin_30:
  ds_read_b32 v16, v1 offset:32
  s_waitcnt lgkmcnt(0)
  v_readfirstlane_b32 s85, v16
  s_cmp_ge_u32 s85, 4
  s_cbranch_scc1 L_spind_31
  s_sleep 2
  s_sub_u32 s84, s84, 1
  s_cmp_lg_u32 s84, 0
  s_cbranch_scc1 L_spin_30
L_spind_31:
  s_mov_b32 s84, 32768
L_poll_32:
  buffer_load_dword v16, v6, s[48:51], s52 offen sc1
  buffer_load_dword v17, v6, s[48:51], s53 offen sc1
  buffer_load_dword v18, v6, s[48:51], s54 offen sc1
  buffer_load_dword v19, v6, s[48:51], s55 offen sc1
  s_waitcnt vmcnt(0)
  v_xor_b32 v16, s72, v16
  v_xor_b32 v17, s72, v17
  v_xor_b32 v18, s72, v18
  v_xor_b32 v19, s72, v19
  v_or3_b32 v20, v16, v17, v18
  v_or_b32 v20, v20, v19
  v_and_b32 v20, 0xff, v20
  v_cmp_ne_u32 vcc, 0, v20
  s_cbranch_vccz L_polld_33
  s_mov_b64 exec, vcc
  s_sleep 2
  s_sub_u32 s84, s84, 1
  s_cmp_lg_u32 s84, 0
  s_cbranch_scc1 L_poll_32
L_polld_33:
  s_mov_b64 exec, -1
  s_add_u32 s85, s73, 1
  v_mov_b32 v16, s85
  s_mov_b64 exec, 1
  buffer_store_dword v16, v1, s[48:51], 0 offen offset:0 sc1
  s_mov_b64 exec, -1
  s_branch L_AUX_END
L_NOBUMP:
  s_cmp_eq_u32 s3, 1
  s_cbranch_scc0 L_AUX_END
  s_lshl_b32 s86, s34, 3
  s_add_u32 s86, s86, s36
  s_lshr_b32 s88, s86, 4
  s_and_b32 s89, s86, 1
  s_bfe_u32 s90, s86, 0x30001
  v_bfe_u32 v6, v0, 1, 2
  v_lshlrev_b32 v6, 17, v6
  v_lshrrev_b32 v8, 3, v0
  v_lshlrev_b32 v8, 11, v8
  v_and_b32 v7, 1, v0
  v_lshlrev_b32 v7, 4, v7
  v_add3_u32 v6, v6, v7, v8
  s_lshl_b32 s87, s35, 19
  s_lshl_b32 s85, s88, 9
  s_add_u32 s87, s87, s85
  s_lshl_b32 s85, s89, 8
  s_add_u32 s87, s87, s85
  s_lshl_b32 s85, s90, 5
  s_add_u32 s87, s87, s85
  s_add_u32 s87, s87, 0x12000
  s_add_u32 s52, s87, 0
  s_add_u32 s53, s87, 16384
  s_mov_b32 s64, s28
  s_and_b32 s65, s29, 0xffff
  s_mov_b32 s66, 0x1000
  s_mov_b32 s67, 0x20000
  s_lshl_b32 s87, s88, 10
  s_lshl_b32 s85, s35, 8
  s_add_u32 s87, s87, s85
  s_lshl_b32 s85, s90, 5
  s_add_u32 s87, s87, s85
  s_lshl_b32 s85, s89, 3
  s_add_u32 s87, s87, s85
  v_lshrrev_b32 v8, 4, v0
  v_lshlrev_b32 v8, 1, v8
  v_add_u32 v7, v7, v8
  s_mov_b32 s60, 0x30003
  s_mov_b32 s61, s60
  s_mov_b32 s84, 1048576
L_spin_35:
  ds_read_b32 v16, v1 offset:32
  s_waitcnt lgkmcnt(0)
  v_readfirstlane_b32 s85, v16
  s_cmp_ge_u32 s85, 4
  s_cbranch_scc1 L_spind_36
  s_sleep 1
  s_sub_u32 s84, s84, 1
  s_cmp_lg_u32 s84, 0
  s_cbranch_scc1 L_spin_35
L_spind_36:
  s_mov_b32 s84, 32768
L_poll_37:
  buffer_load_dwordx4 v[40:43], v6, s[48:51], s52 offen sc1
  buffer_load_dwordx4 v[44:47], v6, s[48:51], s53 offen sc1
  s_waitcnt vmcnt(0)
  v_xor_b32 v40, s72, v40
  v_xor_b32 v41, s72, v41
  v_xor_b32 v42, s72, v42
  v_xor_b32 v43, s72, v43
  v_xor_b32 v44, s72, v44
  v_xor_b32 v45, s72, v45
  v_xor_b32 v46, s72, v46
  v_xor_b32 v47, s72, v47
  v_or3_b32 v16, v40, v41, v42
  v_or3_b32 v16, v16, v43, v44
  v_or3_b32 v16, v16, v45, v46
  v_or_b32 v16, v16, v47
  v_and_b32 v16, 0xff, v16
  v_cmp_ne_u32 vcc, 0, v16
  s_cbranch_vccz L_polld_38
  s_mov_b64 exec, vcc
  s_sub_u32 s84, s84, 1
  s_cmp_lg_u32 s84, 0
  s_cbranch_scc1 L_poll_37
L_polld_38:
  s_mov_b64 exec, -1
  v_add_f32 v40, v40, v44
  v_add_f32 v41, v41, v45
  v_add_f32 v42, v42, v46
  v_add_f32 v43, v43, v47
  v_permlane16_swap_b32 v40, v41
  s_nop 0
  v_permlane16_swap_b32 v42, v43
  v_add_f32 v40, v40, v41
  s_nop 0
  v_add_f32 v42, v42, v43
  s_nop 1
  v_permlane32_swap_b32 v40, v42
  s_nop 0
  v_add_f32 v40, v40, v42
  s_nop 1
  v_add_f32_dpp v40, v40, v40 row_ror:8 row_mask:0xf bank_mask:0xf
  s_nop 1
  v_add_f32_dpp v40, v40, v40 row_ror:4 row_mask:0xf bank_mask:0xf
  s_nop 1
  v_add_f32_dpp v40, v40, v40 row_ror:2 row_mask:0xf bank_mask:0xf
  v_cvt_pk_bf16_f32 v16, v40, v40
  s_mov_b64 exec, s[60:61]
  buffer_store_short v16, v7, s[64:67], s87 offen
  s_mov_b64 exec, -1
L_AUX_END:
  s_endpgm
L_KV:
  s_sub_u32 s39, s3, 4
  s_mov_b32 s42, 0x2000000
  s_mov_b32 s43, 0x20000
  s_mov_b32 s46, 0x2000000
  s_mov_b32 s47, 0x20000
  s_lshl_b32 s85, s35, 3
  s_add_u32 s85, s85, s34
  s_lshl_b32 s85, s85, 20
  s_lshl_b32 s86, s36, 16
  s_add_u32 s85, s85, s86
  s_lshl_b32 s86, s39, 13
  s_add_u32 s85, s85, s86
  s_mov_b32 s93, s85
  s_add_u32 s94, s93, 4096
  s_add_u32 s95, s93, 524288
  s_add_u32 s96, s93, 528384
  v_and_b32 v4, 3, v0
  v_lshlrev_b32 v4, 10, v4
  v_bfe_u32 v5, v0, 2, 2
  v_lshlrev_b32 v5, 8, v5
  v_and_b32 v6, 0x30, v0
  v_add3_u32 v1, v4, v5, v6
  v_bfe_u32 v5, v0, 2, 1
  v_lshlrev_b32 v5, 8, v5
  v_bfe_u32 v7, v0, 3, 1
  v_lshlrev_b32 v7, 6, v7
  v_add3_u32 v4, v4, v5, v6
  v_add_u32 v1, v4, v7
  v_lshlrev_b32 v2, 4, v0
  v_mov_b32 v3, 0
  v_mov_b32 v38, 1
  s_waitcnt lgkmcnt(0)
  s_mov_b64 s[40:41], s[10:11]
  s_mov_b64 s[44:45], s[12:13]
  s_load_dword s73, s[32:33], 0
  s_barrier
  s_setprio 2
  buffer_load_dwordx4 v[40:43], v1, s[40:43], s93 offen offset:0 nt
  buffer_load_dwordx4 v[44:47], v1, s[40:43], s93 offen offset:128 nt
  buffer_load_dwordx4 v[48:51], v1, s[40:43], s93 offen offset:512 nt
  buffer_load_dwordx4 v[52:55], v1, s[40:43], s93 offen offset:640 nt
  buffer_load_dwordx4 v[56:59], v1, s[40:43], s94 offen offset:0 nt
  buffer_load_dwordx4 v[60:63], v1, s[40:43], s94 offen offset:128 nt
  s_waitcnt vmcnt(5)
  buffer_load_dwordx4 v[64:67], v1, s[40:43], s94 offen offset:512 nt
  s_waitcnt vmcnt(5)
  buffer_load_dwordx4 v[68:71], v1, s[40:43], s94 offen offset:640 nt
  s_waitcnt vmcnt(5)
  buffer_load_dwordx4 v[72:75], v1, s[40:43], s95 offen offset:0 nt
  s_waitcnt vmcnt(5)
  buffer_load_dwordx4 v[76:79], v1, s[40:43], s95 offen offset:128 nt
  s_waitcnt vmcnt(5)
  buffer_load_dwordx4 v[80:83], v1, s[40:43], s95 offen offset:512 nt
  s_waitcnt vmcnt(5)
  buffer_load_dwordx4 v[84:87], v1, s[40:43], s95 offen offset:640 nt
  s_waitcnt vmcnt(5)
  buffer_load_dwordx4 v[88:91], v1, s[40:43], s96 offen offset:0 nt
  s_waitcnt vmcnt(5)
  buffer_load_dwordx4 v[92:95], v1, s[40:43], s96 offen offset:128 nt
  s_waitcnt vmcnt(5)
  buffer_load_dwordx4 v[96:99], v1, s[40:43], s96 offen offset:512 nt
  s_waitcnt vmcnt(5)
  buffer_load_dwordx4 v[100:103], v1, s[40:43], s96 offen offset:640 nt
  s_setprio 1
  v_bfe_u32 v5, v0, 2, 2
  v_mul_u32_u24 v5, 272, v5
  v_and_b32 v6, 0x30, v0
  v_add_u32 v1, v5, v6
  v_and_b32 v5, 1, v0
  v_lshlrev_b32 v5, 6, v5
  v_add_u32 v1, v5, v1
  s_mov_b64 exec, 1
  ds_add_u32 v3, v38 offset:12
  s_mov_b64 exec, -1
  s_cmp_ge_u32 s39, 4
  s_cbranch_scc1 L_B3
  s_mov_b32 s84, 1048576
L_spin_40:
  ds_read_b32 v36, v3 offset:12
  s_waitcnt lgkmcnt(0)
  v_readfirstlane_b32 s85, v36
  s_cmp_ge_u32 s85, 8
  s_cbranch_scc1 L_spind_41
  s_sleep 2
  s_sub_u32 s84, s84, 1
  s_cmp_lg_u32 s84, 0
  s_cbranch_scc1 L_spin_40
L_spind_41:
  s_setprio 1
  s_waitcnt vmcnt(5)
  buffer_load_dwordx4 v[104:107], v2, s[44:47], s93 offen offset:0 nt
  s_waitcnt vmcnt(5)
  buffer_load_dwordx4 v[108:111], v2, s[44:47], s93 offen offset:1024 nt
  s_waitcnt vmcnt(5)
  buffer_load_dwordx4 v[112:115], v2, s[44:47], s93 offen offset:2048 nt
  s_waitcnt vmcnt(5)
  buffer_load_dwordx4 v[116:119], v2, s[44:47], s93 offen offset:3072 nt
  s_waitcnt vmcnt(5)
  buffer_load_dwordx4 v[120:123], v2, s[44:47], s94 offen offset:0 nt
  s_waitcnt vmcnt(5)
  buffer_load_dwordx4 v[124:127], v2, s[44:47], s94 offen offset:1024 nt
  s_waitcnt vmcnt(5)
  buffer_load_dwordx4 v[128:131], v2, s[44:47], s94 offen offset:2048 nt
  s_waitcnt vmcnt(5)
  buffer_load_dwordx4 v[132:135], v2, s[44:47], s94 offen offset:3072 nt
  s_setprio 0
  buffer_load_dwordx4 v[136:139], v2, s[44:47], s95 offen offset:0 nt
  buffer_load_dwordx4 v[140:143], v2, s[44:47], s95 offen offset:1024 nt
  buffer_load_dwordx4 v[144:147], v2, s[44:47], s95 offen offset:2048 nt
  buffer_load_dwordx4 v[148:151], v2, s[44:47], s95 offen offset:3072 nt
  buffer_load_dwordx4 v[152:155], v2, s[44:47], s96 offen offset:0 nt
  buffer_load_dwordx4 v[156:159], v2, s[44:47], s96 offen offset:1024 nt
  buffer_load_dwordx4 v[160:163], v2, s[44:47], s96 offen offset:2048 nt
  buffer_load_dwordx4 v[164:167], v2, s[44:47], s96 offen offset:3072 nt
  s_mov_b64 exec, 1
  ds_add_u32 v3, v38 offset:28
  s_mov_b64 exec, -1
  s_mov_b32 s97, 1
  s_setprio 2
  s_mov_b32 s84, 1048576
L_spin_42:
  ds_read_b32 v36, v3 offset:8
  s_waitcnt lgkmcnt(0)
  v_readfirstlane_b32 s85, v36
  s_cmp_ge_u32 s85, 4
  s_cbranch_scc1 L_spind_43
  s_sleep 2
  s_sub_u32 s84, s84, 1
  s_cmp_lg_u32 s84, 0
  s_cbranch_scc1 L_spin_42
L_spind_43:
  s_waitcnt vmcnt(16)
  s_branch L_QK
L_B3:
  s_mov_b32 s97, 0
  s_setprio 2
  s_mov_b32 s84, 1048576
L_spin_44:
  ds_read_b32 v36, v3 offset:8
  s_waitcnt lgkmcnt(0)
  v_readfirstlane_b32 s85, v36
  s_cmp_ge_u32 s85, 4
  s_cbranch_scc1 L_spind_45
  s_sleep 2
  s_sub_u32 s84, s84, 1
  s_cmp_lg_u32 s84, 0
  s_cbranch_scc1 L_spin_44
L_spind_45:
  s_waitcnt vmcnt(0)
L_QK:
  ds_read_b128 v[4:7], v1 offset:512
  ds_read_b128 v[8:11], v1 offset:640
  s_waitcnt lgkmcnt(0)
  v_mfma_f32_16x16x32_bf16 v[20:23], v[40:43], v[4:7], 0
  v_mfma_f32_16x16x32_bf16 v[12:15], v[48:51], v[4:7], 0
  v_mfma_f32_16x16x32_bf16 v[20:23], v[44:47], v[8:11], v[20:23]
  v_mfma_f32_16x16x32_bf16 v[12:15], v[52:55], v[8:11], v[12:15]
  v_mfma_f32_16x16x32_bf16 v[24:27], v[56:59], v[4:7], 0
  v_mfma_f32_16x16x32_bf16 v[16:19], v[64:67], v[4:7], 0
  v_mfma_f32_16x16x32_bf16 v[24:27], v[60:63], v[8:11], v[24:27]
  v_mfma_f32_16x16x32_bf16 v[16:19], v[68:71], v[8:11], v[16:19]
  v_mfma_f32_16x16x32_bf16 v[28:31], v[72:75], v[4:7], 0
  v_mfma_f32_16x16x32_bf16 v[40:43], v[80:83], v[4:7], 0
  v_mfma_f32_16x16x32_bf16 v[28:31], v[76:79], v[8:11], v[28:31]
  v_mfma_f32_16x16x32_bf16 v[40:43], v[84:87], v[8:11], v[40:43]
  v_mfma_f32_16x16x32_bf16 v[32:35], v[88:91], v[4:7], 0
  v_mfma_f32_16x16x32_bf16 v[44:47], v[96:99], v[4:7], 0
  v_mfma_f32_16x16x32_bf16 v[32:35], v[92:95], v[8:11], v[32:35]
  v_mfma_f32_16x16x32_bf16 v[44:47], v[100:103], v[8:11], v[44:47]
  s_nop 7
  v_permlane32_swap_b32 v20, v12
  v_permlane32_swap_b32 v21, v13
  v_permlane32_swap_b32 v22, v14
  v_permlane32_swap_b32 v23, v15
  v_permlane32_swap_b32 v24, v16
  v_permlane32_swap_b32 v25, v17
  v_permlane32_swap_b32 v26, v18
  v_permlane32_swap_b32 v27, v19
  v_permlane32_swap_b32 v28, v40
  v_permlane32_swap_b32 v29, v41
  v_permlane32_swap_b32 v30, v42
  v_permlane32_swap_b32 v31, v43
  v_permlane32_swap_b32 v32, v44
  v_permlane32_swap_b32 v33, v45
  v_permlane32_swap_b32 v34, v46
  v_permlane32_swap_b32 v35, v47
  v_add_f32_dpp v20, v12, v20 quad_perm:[1,1,3,3] row_mask:0xf bank_mask:0xf
  v_add_f32_dpp v21, v13, v21 quad_perm:[1,1,3,3] row_mask:0xf bank_mask:0xf
  v_add_f32_dpp v22, v14, v22 quad_perm:[1,1,3,3] row_mask:0xf bank_mask:0xf
  v_add_f32_dpp v23, v15, v23 quad_perm:[1,1,3,3] row_mask:0xf bank_mask:0xf
  v_add_f32_dpp v24, v16, v24 quad_perm:[1,1,3,3] row_mask:0xf bank_mask:0xf
  v_add_f32_dpp v25, v17, v25 quad_perm:[1,1,3,3] row_mask:0xf bank_mask:0xf
  v_add_f32_dpp v26, v18, v26 quad_perm:[1,1,3,3] row_mask:0xf bank_mask:0xf
  v_add_f32_dpp v27, v19, v27 quad_perm:[1,1,3,3] row_mask:0xf bank_mask:0xf
  v_add_f32_dpp v28, v40, v28 quad_perm:[1,1,3,3] row_mask:0xf bank_mask:0xf
  v_add_f32_dpp v29, v41, v29 quad_perm:[1,1,3,3] row_mask:0xf bank_mask:0xf
  v_add_f32_dpp v30, v42, v30 quad_perm:[1,1,3,3] row_mask:0xf bank_mask:0xf
  v_add_f32_dpp v31, v43, v31 quad_perm:[1,1,3,3] row_mask:0xf bank_mask:0xf
  v_add_f32_dpp v32, v44, v32 quad_perm:[1,1,3,3] row_mask:0xf bank_mask:0xf
  v_add_f32_dpp v33, v45, v33 quad_perm:[1,1,3,3] row_mask:0xf bank_mask:0xf
  v_add_f32_dpp v34, v46, v34 quad_perm:[1,1,3,3] row_mask:0xf bank_mask:0xf
  v_add_f32_dpp v35, v47, v35 quad_perm:[1,1,3,3] row_mask:0xf bank_mask:0xf
  v_cvt_pk_bf16_f32 v36, v20, v21
  v_lshlrev_b32 v20, 16, v36
  v_and_b32 v21, 0xffff0000, v36
  v_cvt_pk_bf16_f32 v37, v22, v23
  v_lshlrev_b32 v22, 16, v37
  v_and_b32 v23, 0xffff0000, v37
  v_cvt_pk_bf16_f32 v36, v24, v25
  v_lshlrev_b32 v24, 16, v36
  v_and_b32 v25, 0xffff0000, v36
  v_cvt_pk_bf16_f32 v37, v26, v27
  v_lshlrev_b32 v26, 16, v37
  v_and_b32 v27, 0xffff0000, v37
  v_cvt_pk_bf16_f32 v36, v28, v29
  v_lshlrev_b32 v28, 16, v36
  v_and_b32 v29, 0xffff0000, v36
  v_cvt_pk_bf16_f32 v37, v30, v31
  v_lshlrev_b32 v30, 16, v37
  v_and_b32 v31, 0xffff0000, v37
  v_cvt_pk_bf16_f32 v36, v32, v33
  v_lshlrev_b32 v32, 16, v36
  v_and_b32 v33, 0xffff0000, v36
  v_cvt_pk_bf16_f32 v37, v34, v35
  v_lshlrev_b32 v34, 16, v37
  v_and_b32 v35, 0xffff0000, v37
  v_mul_f32 v20, 0x3db504f3, v20
  v_mul_f32 v21, 0x3db504f3, v21
  v_mul_f32 v22, 0x3db504f3, v22
  v_mul_f32 v23, 0x3db504f3, v23
  v_mul_f32 v24, 0x3db504f3, v24
  v_mul_f32 v25, 0x3db504f3, v25
  v_mul_f32 v26, 0x3db504f3, v26
  v_mul_f32 v27, 0x3db504f3, v27
  v_mul_f32 v28, 0x3db504f3, v28
  v_mul_f32 v29, 0x3db504f3, v29
  v_mul_f32 v30, 0x3db504f3, v30
  v_mul_f32 v31, 0x3db504f3, v31
  v_mul_f32 v32, 0x3db504f3, v32
  v_mul_f32 v33, 0x3db504f3, v33
  v_mul_f32 v34, 0x3db504f3, v34
  v_mul_f32 v35, 0x3db504f3, v35
  v_cvt_pk_bf16_f32 v36, v20, v21
  v_lshlrev_b32 v20, 16, v36
  v_and_b32 v21, 0xffff0000, v36
  v_cvt_pk_bf16_f32 v37, v22, v23
  v_lshlrev_b32 v22, 16, v37
  v_and_b32 v23, 0xffff0000, v37
  v_cvt_pk_bf16_f32 v36, v24, v25
  v_lshlrev_b32 v24, 16, v36
  v_and_b32 v25, 0xffff0000, v36
  v_cvt_pk_bf16_f32 v37, v26, v27
  v_lshlrev_b32 v26, 16, v37
  v_and_b32 v27, 0xffff0000, v37
  v_cvt_pk_bf16_f32 v36, v28, v29
  v_lshlrev_b32 v28, 16, v36
  v_and_b32 v29, 0xffff0000, v36
  v_cvt_pk_bf16_f32 v37, v30, v31
  v_lshlrev_b32 v30, 16, v37
  v_and_b32 v31, 0xffff0000, v37
  v_cvt_pk_bf16_f32 v36, v32, v33
  v_lshlrev_b32 v32, 16, v36
  v_and_b32 v33, 0xffff0000, v36
  v_cvt_pk_bf16_f32 v37, v34, v35
  v_lshlrev_b32 v34, 16, v37
  v_and_b32 v35, 0xffff0000, v37
  v_max3_f32 v4, v20, v21, v22
  v_max3_f32 v6, v23, v24, v25
  v_max3_f32 v7, v26, v27, v28
  v_max3_f32 v8, v29, v30, v31
  v_max3_f32 v9, v32, v33, v34
  v_max3_f32 v4, v4, v6, v7
  v_max3_f32 v8, v8, v9, v35
  v_max_f32 v4, v4, v8
  v_mov_b32 v6, v4
  s_nop 1
  v_permlane16_swap_b32 v4, v6
  s_nop 0
  v_max_f32 v4, v4, v6
  v_mov_b32 v6, v4
  s_nop 1
  v_permlane32_swap_b32 v4, v6
  s_nop 0
  v_max_f32 v4, v4, v6
  v_mul_f32 v6, s92, v4
  v_fma_f32 v20, v20, s92, -v6
  v_fma_f32 v21, v21, s92, -v6
  v_fma_f32 v22, v22, s92, -v6
  v_fma_f32 v23, v23, s92, -v6
  v_fma_f32 v24, v24, s92, -v6
  v_fma_f32 v25, v25, s92, -v6
  v_fma_f32 v26, v26, s92, -v6
  v_fma_f32 v27, v27, s92, -v6
  v_fma_f32 v28, v28, s92, -v6
  v_fma_f32 v29, v29, s92, -v6
  v_fma_f32 v30, v30, s92, -v6
  v_fma_f32 v31, v31, s92, -v6
  v_fma_f32 v32, v32, s92, -v6
  v_fma_f32 v33, v33, s92, -v6
  v_fma_f32 v34, v34, s92, -v6
  v_fma_f32 v35, v35, s92, -v6
  v_exp_f32 v20, v20
  v_exp_f32 v21, v21
  v_exp_f32 v22, v22
  v_exp_f32 v23, v23
  v_exp_f32 v24, v24
  v_exp_f32 v25, v25
  v_exp_f32 v26, v26
  v_exp_f32 v27, v27
  v_exp_f32 v28, v28
  v_exp_f32 v29, v29
  v_exp_f32 v30, v30
  v_exp_f32 v31, v31
  v_exp_f32 v32, v32
  v_exp_f32 v33, v33
  v_exp_f32 v34, v34
  v_exp_f32 v35, v35
  s_nop 0
  v_add_f32 v5, v20, v21
  v_add_f32 v7, v22, v23
  v_add_f32 v5, v5, v24
  v_add_f32 v7, v7, v25
  v_add_f32 v5, v5, v26
  v_add_f32 v7, v7, v27
  v_add_f32 v5, v5, v28
  v_add_f32 v7, v7, v29
  v_add_f32 v5, v5, v30
  v_add_f32 v7, v7, v31
  v_add_f32 v5, v5, v32
  v_add_f32 v7, v7, v33
  v_add_f32 v5, v5, v34
  v_add_f32 v7, v7, v35
  v_add_f32 v5, v5, v7
  v_cvt_pk_bf16_f32 v8, v20, v21
  v_cvt_pk_bf16_f32 v9, v22, v23
  v_cvt_pk_bf16_f32 v10, v24, v25
  v_cvt_pk_bf16_f32 v11, v26, v27
  v_cvt_pk_bf16_f32 v12, v28, v29
  v_cvt_pk_bf16_f32 v13, v30, v31
  v_cvt_pk_bf16_f32 v14, v32, v33
  v_cvt_pk_bf16_f32 v15, v34, v35
  v_mov_b32 v6, v5
  s_nop 1
  v_permlane16_swap_b32 v5, v6
  s_nop 0
  v_add_f32 v5, v5, v6
  v_mov_b32 v6, v5
  s_nop 1
  v_permlane32_swap_b32 v5, v6
  s_nop 0
  v_add_f32 v5, v5, v6
  v_lshlrev_b32 v6, 3, v0
  s_lshl_b32 s85, s39, 2
  v_add_u32 v6, s85, v6
  s_mov_b64 exec, 0x1111
  ds_write_b32 v6, v4 offset:256
  ds_write_b32 v6, v5 offset:384
  s_mov_b64 exec, 1
  ds_add_u32 v3, v38 offset:16
  s_mov_b64 exec, -1
  s_cmp_eq_u32 s97, 1
  s_cbranch_scc1 L_V1D
  s_setprio 1
  s_waitcnt vmcnt(5)
  buffer_load_dwordx4 v[104:107], v2, s[44:47], s93 offen offset:0 nt
  s_waitcnt vmcnt(5)
  buffer_load_dwordx4 v[108:111], v2, s[44:47], s93 offen offset:1024 nt
  s_waitcnt vmcnt(5)
  buffer_load_dwordx4 v[112:115], v2, s[44:47], s93 offen offset:2048 nt
  s_waitcnt vmcnt(5)
  buffer_load_dwordx4 v[116:119], v2, s[44:47], s93 offen offset:3072 nt
  s_waitcnt vmcnt(5)
  buffer_load_dwordx4 v[120:123], v2, s[44:47], s94 offen offset:0 nt
  s_waitcnt vmcnt(5)
  buffer_load_dwordx4 v[124:127], v2, s[44:47], s94 offen offset:1024 nt
  s_waitcnt vmcnt(5)
  buffer_load_dwordx4 v[128:131], v2, s[44:47], s94 offen offset:2048 nt
  s_waitcnt vmcnt(5)
  buffer_load_dwordx4 v[132:135], v2, s[44:47], s94 offen offset:3072 nt
L_V0D:
  s_setprio 0
  buffer_load_dwordx4 v[136:139], v2, s[44:47], s95 offen offset:0 nt
  buffer_load_dwordx4 v[140:143], v2, s[44:47], s95 offen offset:1024 nt
  buffer_load_dwordx4 v[144:147], v2, s[44:47], s95 offen offset:2048 nt
  buffer_load_dwordx4 v[148:151], v2, s[44:47], s95 offen offset:3072 nt
  buffer_load_dwordx4 v[152:155], v2, s[44:47], s96 offen offset:0 nt
  buffer_load_dwordx4 v[156:159], v2, s[44:47], s96 offen offset:1024 nt
  buffer_load_dwordx4 v[160:163], v2, s[44:47], s96 offen offset:2048 nt
  buffer_load_dwordx4 v[164:167], v2, s[44:47], s96 offen offset:3072 nt
  s_mov_b64 exec, 1
  ds_add_u32 v3, v38 offset:28
  s_mov_b64 exec, -1
L_V1D:
  s_cmp_ge_u32 s39, 4
  s_cbranch_scc1 L_KVB
  s_setprio 2
  s_waitcnt vmcnt(8)
  v_perm_b32 v40, v108, v104, s74
  v_perm_b32 v41, v116, v112, s74
  v_perm_b32 v42, v124, v120, s74
  v_perm_b32 v43, v132, v128, s74
  v_perm_b32 v44, v108, v104, s75
  v_perm_b32 v45, v116, v112, s75
  v_perm_b32 v46, v124, v120, s75
  v_perm_b32 v47, v132, v128, s75
  v_mfma_f32_16x16x32_bf16 v[72:75], v[8:11], v[40:43], 0
  v_perm_b32 v48, v109, v105, s74
  v_perm_b32 v49, v117, v113, s74
  v_perm_b32 v50, v125, v121, s74
  v_perm_b32 v51, v133, v129, s74
  v_mfma_f32_16x16x32_bf16 v[76:79], v[8:11], v[44:47], 0
  v_perm_b32 v52, v109, v105, s75
  v_perm_b32 v53, v117, v113, s75
  v_perm_b32 v54, v125, v121, s75
  v_perm_b32 v55, v133, v129, s75
  v_mfma_f32_16x16x32_bf16 v[80:83], v[8:11], v[48:51], 0
  v_perm_b32 v56, v110, v106, s74
  v_perm_b32 v57, v118, v114, s74
  v_perm_b32 v58, v126, v122, s74
  v_perm_b32 v59, v134, v130, s74
  v_mfma_f32_16x16x32_bf16 v[84:87], v[8:11], v[52:55], 0
  v_perm_b32 v60, v110, v106, s75
  v_perm_b32 v61, v118, v114, s75
  v_perm_b32 v62, v126, v122, s75
  v_perm_b32 v63, v134, v130, s75
  v_mfma_f32_16x16x32_bf16 v[88:91], v[8:11], v[56:59], 0
  v_perm_b32 v64, v111, v107, s74
  v_perm_b32 v65, v119, v115, s74
  v_perm_b32 v66, v127, v123, s74
  v_perm_b32 v67, v135, v131, s74
  v_mfma_f32_16x16x32_bf16 v[92:95], v[8:11], v[60:63], 0
  v_perm_b32 v68, v111, v107, s75
  v_perm_b32 v69, v119, v115, s75
  v_perm_b32 v70, v127, v123, s75
  v_perm_b32 v71, v135, v131, s75
  v_mfma_f32_16x16x32_bf16 v[96:99], v[8:11], v[64:67], 0
  s_nop 1
  v_mfma_f32_16x16x32_bf16 v[100:103], v[8:11], v[68:71], 0
  s_mov_b32 s84, 1048576
L_spin_46:
  ds_read_b32 v36, v3 offset:16
  s_waitcnt lgkmcnt(0)
  v_readfirstlane_b32 s85, v36
  s_cmp_ge_u32 s85, 8
  s_cbranch_scc1 L_spind_47
  s_sleep 1
  s_sub_u32 s84, s84, 1
  s_cmp_lg_u32 s84, 0
  s_cbranch_scc1 L_spin_46
L_spind_47:
  v_lshrrev_b32 v6, 4, v0
  v_lshlrev_b32 v6, 5, v6
  ds_read_b128 v[16:19], v6 offset:256
  ds_read_b128 v[20:23], v6 offset:272
  s_lshl_b32 s85, s39, 2
  v_add_u32 v7, s85, v6
  ds_read_b32 v24, v7 offset:256
  s_waitcnt lgkmcnt(0)
  v_max3_f32 v16, v16, v17, v18
  v_max3_f32 v19, v19, v20, v21
  v_max3_f32 v16, v16, v22, v23
  v_max_f32 v16, v16, v19
  v_sub_f32 v24, v24, v16
  v_mul_f32 v24, s92, v24
  v_exp_f32 v24, v24
  v_lshrrev_b32 v6, 4, v0
  v_lshlrev_b32 v6, 9, v6
  v_and_b32 v7, 15, v0
  v_lshlrev_b32 v7, 4, v7
  s_lshl_b32 s85, s39, 11
  v_add3_u32 v6, v6, v7, s85
  s_waitcnt vmcnt(6)
  v_perm_b32 v40, v140, v136, s74
  v_perm_b32 v44, v140, v136, s75
  v_perm_b32 v48, v141, v137, s74
  v_perm_b32 v52, v141, v137, s75
  v_perm_b32 v56, v142, v138, s74
  v_perm_b32 v60, v142, v138, s75
  v_perm_b32 v64, v143, v139, s74
  v_perm_b32 v68, v143, v139, s75
  s_waitcnt vmcnt(4)
  v_perm_b32 v41, v148, v144, s74
  v_perm_b32 v45, v148, v144, s75
  v_perm_b32 v49, v149, v145, s74
  v_perm_b32 v53, v149, v145, s75
  v_perm_b32 v57, v150, v146, s74
  v_perm_b32 v61, v150, v146, s75
  v_perm_b32 v65, v151, v147, s74
  v_perm_b32 v69, v151, v147, s75
  s_waitcnt vmcnt(2)
  v_perm_b32 v42, v156, v152, s74
  v_perm_b32 v46, v156, v152, s75
  v_perm_b32 v50, v157, v153, s74
  v_perm_b32 v54, v157, v153, s75
  v_perm_b32 v58, v158, v154, s74
  v_perm_b32 v62, v158, v154, s75
  v_perm_b32 v66, v159, v155, s74
  v_perm_b32 v70, v159, v155, s75
  s_waitcnt vmcnt(0)
  v_perm_b32 v43, v164, v160, s74
  v_perm_b32 v47, v164, v160, s75
  v_perm_b32 v51, v165, v161, s74
  v_perm_b32 v55, v165, v161, s75
  v_perm_b32 v59, v166, v162, s74
  v_perm_b32 v63, v166, v162, s75
  v_perm_b32 v67, v167, v163, s74
  v_perm_b32 v71, v167, v163, s75
  s_nop 1
  v_mfma_f32_16x16x32_bf16 v[72:75], v[12:15], v[40:43], v[72:75]
  v_mfma_f32_16x16x32_bf16 v[76:79], v[12:15], v[44:47], v[76:79]
  v_mfma_f32_16x16x32_bf16 v[80:83], v[12:15], v[48:51], v[80:83]
  v_mfma_f32_16x16x32_bf16 v[84:87], v[12:15], v[52:55], v[84:87]
  v_mfma_f32_16x16x32_bf16 v[88:91], v[12:15], v[56:59], v[88:91]
  v_mfma_f32_16x16x32_bf16 v[92:95], v[12:15], v[60:63], v[92:95]
  v_mfma_f32_16x16x32_bf16 v[96:99], v[12:15], v[64:67], v[96:99]
  v_mfma_f32_16x16x32_bf16 v[100:103], v[12:15], v[68:71], v[100:103]
  s_nop 7
  v_mul_f32 v16, v24, v72
  v_mul_f32 v17, v24, v76
  v_mul_f32 v18, v24, v80
  v_mul_f32 v19, v24, v84
  v_mul_f32 v20, v24, v88
  v_mul_f32 v21, v24, v92
  v_mul_f32 v22, v24, v96
  v_mul_f32 v23, v24, v100
  ds_write_b128 v6, v[16:19] offset:10752
  ds_write_b128 v6, v[20:23] offset:11008
  s_mov_b64 exec, 1
  ds_add_u32 v3, v38 offset:20
  s_mov_b64 exec, -1
  s_mov_b32 s48, s32
  s_and_b32 s49, s33, 0xffff
  s_mov_b32 s50, 0x400000
  s_mov_b32 s51, 0x20000
  s_add_u32 s72, s73, 1
  s_and_b32 s72, s72, 0xff
  v_lshrrev_b32 v4, 4, v0
  s_lshl_b32 s90, s39, 3
  s_add_u32 s90, s90, s34
  v_bfe_u32 v8, v0, 1, 3
  v_lshlrev_b32 v9, 9, v8
  v_lshlrev_b32 v10, 5, v4
  v_and_b32 v11, 1, v0
  v_lshlrev_b32 v11, 4, v11
  v_add3_u32 v5, v9, v10, v11
  v_lshlrev_b32 v6, 4, v8
  s_lshr_b32 s85, s36, 1
  s_lshl_b32 s85, s85, 2
  s_and_b32 s86, s90, 3
  s_add_u32 s85, s85, s86
  s_lshl_b32 s85, s85, 17
  s_lshr_b32 s86, s90, 2
  s_lshl_b32 s94, s86, 12
  s_add_u32 s94, s94, s85
  s_and_b32 s87, s36, 1
  s_lshl_b32 s87, s87, 8
  s_add_u32 s94, s94, s87
  s_add_u32 s94, s94, 0xa000
  s_lshl_b32 s95, s86, 7
  s_add_u32 s95, s95, s85
  s_add_u32 s95, s95, 0x9000
  v_lshlrev_b32 v9, 4, v4
  v_and_b32 v10, 1, v0
  v_lshlrev_b32 v10, 3, v10
  s_lshl_b32 s85, s39, 7
  v_add3_u32 v7, v9, v10, s85
  s_mov_b32 s84, 1048576
L_spin_48:
  ds_read_b32 v28, v3 offset:44
  s_waitcnt lgkmcnt(0)
  v_readfirstlane_b32 s85, v28
  s_cmp_ge_u32 s85, 1
  s_cbranch_scc1 L_spind_49
  s_sleep 1
  s_sub_u32 s84, s84, 1
  s_cmp_lg_u32 s84, 0
  s_cbranch_scc1 L_spin_48
L_spind_49:
  s_cmp_eq_u32 s85, 2
  s_cselect_b32 s85, 0x200000, 0
  s_add_u32 s94, s94, s85
  s_add_u32 s95, s95, s85
  s_mov_b32 s84, 1048576
L_spin_50:
  ds_read_b32 v28, v3 offset:20
  s_waitcnt lgkmcnt(0)
  v_readfirstlane_b32 s85, v28
  s_cmp_ge_u32 s85, 8
  s_cbranch_scc1 L_spind_51
  s_sub_u32 s84, s84, 1
  s_cmp_lg_u32 s84, 0
  s_cbranch_scc1 L_spin_50
L_spind_51:
  s_mov_b32 s84, 32768
  buffer_load_dwordx4 v[64:67], v6, s[48:51], s95 offen sc1
  buffer_load_dwordx4 v[40:43], v5, s[48:51], s94 offen sc1
  buffer_load_dwordx4 v[44:47], v5, s[48:51], s94 offen offset:128 sc1
  s_waitcnt vmcnt(2)
  s_branch L_pollc_55
L_poll_52:
  buffer_load_dwordx4 v[64:67], v6, s[48:51], s95 offen sc1
  s_waitcnt vmcnt(0)
L_pollc_55:
  v_xor_b32 v64, s72, v64
  v_xor_b32 v65, s72, v65
  v_xor_b32 v66, s72, v66
  v_xor_b32 v67, s72, v67
  v_or3_b32 v28, v64, v65, v66
  v_or_b32 v28, v28, v67
  v_and_b32 v28, 0xff, v28
  v_cmp_ne_u32 vcc, 0, v28
  s_cbranch_vccz L_polld_53
  s_mov_b64 exec, vcc
  s_sleep 2
  s_sub_u32 s84, s84, 1
  s_cmp_lg_u32 s84, 0
  s_cbranch_scc1 L_poll_52
L_polld_53:
  s_mov_b64 exec, -1
  v_mov_b32 v28, v64
  s_nop 1
  v_max_f32_dpp v28, v28, v28 row_ror:2 row_mask:0xf bank_mask:0xf
  s_nop 1
  v_max_f32_dpp v28, v28, v28 row_ror:4 row_mask:0xf bank_mask:0xf
  s_nop 1
  v_max_f32_dpp v28, v28, v28 row_ror:8 row_mask:0xf bank_mask:0xf
  v_sub_f32 v28, v64, v28
  v_mul_f32 v28, s92, v28
  v_exp_f32 v28, v28
  s_nop 0
  v_mul_f32 v29, v28, v65
  s_nop 1
  v_add_f32_dpp v29, v29, v29 row_ror:2 row_mask:0xf bank_mask:0xf
  s_nop 1
  v_add_f32_dpp v29, v29, v29 row_ror:4 row_mask:0xf bank_mask:0xf
  s_nop 1
  v_add_f32_dpp v29, v29, v29 row_ror:8 row_mask:0xf bank_mask:0xf
  v_rcp_f32 v29, v29
  s_nop 0
  v_mul_f32 v30, v28, v29
  s_add_u32 s96, s94, 0x200000
  s_mov_b32 s84, 32768
  s_branch L_pollw_58
L_poll_56:
  buffer_load_dwordx4 v[40:43], v5, s[48:51], s94 offen sc1
  buffer_load_dwordx4 v[44:47], v5, s[48:51], s94 offen offset:128 sc1
L_pollw_58:
  s_waitcnt vmcnt(0)
  v_xor_b32 v40, s72, v40
  v_xor_b32 v41, s72, v41
  v_xor_b32 v42, s72, v42
  v_xor_b32 v43, s72, v43
  v_xor_b32 v44, s72, v44
  v_xor_b32 v45, s72, v45
  v_xor_b32 v46, s72, v46
  v_xor_b32 v47, s72, v47
  v_or3_b32 v28, v40, v41, v42
  v_or3_b32 v28, v28, v43, v44
  v_or3_b32 v28, v28, v45, v46
  v_or_b32 v28, v28, v47
  v_and_b32 v28, 0xff, v28
  v_cmp_ne_u32 vcc, 0, v28
  s_cbranch_vccz L_polld_57
  s_mov_b64 exec, vcc
  s_sub_u32 s84, s84, 1
  s_cmp_lg_u32 s84, 0
  s_cbranch_scc1 L_poll_56
L_polld_57:
  s_mov_b64 exec, -1
  v_mul_f32 v40, v30, v40
  v_mul_f32 v41, v30, v41
  v_mul_f32 v42, v30, v42
  v_mul_f32 v43, v30, v43
  v_mul_f32 v44, v30, v44
  v_mul_f32 v45, v30, v45
  v_mul_f32 v46, v30, v46
  v_mul_f32 v47, v30, v47
  v_add_f32_dpp v40, v40, v40 row_ror:2 row_mask:0xf bank_mask:0xf
  v_add_f32_dpp v41, v41, v41 row_ror:2 row_mask:0xf bank_mask:0xf
  v_add_f32_dpp v42, v42, v42 row_ror:2 row_mask:0xf bank_mask:0xf
  v_add_f32_dpp v43, v43, v43 row_ror:2 row_mask:0xf bank_mask:0xf
  v_add_f32_dpp v44, v44, v44 row_ror:2 row_mask:0xf bank_mask:0xf
  v_add_f32_dpp v45, v45, v45 row_ror:2 row_mask:0xf bank_mask:0xf
  v_add_f32_dpp v46, v46, v46 row_ror:2 row_mask:0xf bank_mask:0xf
  v_add_f32_dpp v47, v47, v47 row_ror:2 row_mask:0xf bank_mask:0xf
  v_add_f32_dpp v40, v40, v40 row_ror:4 row_mask:0xf bank_mask:0xf
  v_add_f32_dpp v41, v41, v41 row_ror:4 row_mask:0xf bank_mask:0xf
  v_add_f32_dpp v42, v42, v42 row_ror:4 row_mask:0xf bank_mask:0xf
  v_add_f32_dpp v43, v43, v43 row_ror:4 row_mask:0xf bank_mask:0xf
  v_add_f32_dpp v44, v44, v44 row_ror:4 row_mask:0xf bank_mask:0xf
  v_add_f32_dpp v45, v45, v45 row_ror:4 row_mask:0xf bank_mask:0xf
  v_add_f32_dpp v46, v46, v46 row_ror:4 row_mask:0xf bank_mask:0xf
  v_add_f32_dpp v47, v47, v47 row_ror:4 row_mask:0xf bank_mask:0xf
  v_add_f32_dpp v40, v40, v40 row_ror:8 row_mask:0xf bank_mask:0xf
  v_add_f32_dpp v41, v41, v41 row_ror:8 row_mask:0xf bank_mask:0xf
  v_add_f32_dpp v42, v42, v42 row_ror:8 row_mask:0xf bank_mask:0xf
  v_add_f32_dpp v43, v43, v43 row_ror:8 row_mask:0xf bank_mask:0xf
  v_add_f32_dpp v44, v44, v44 row_ror:8 row_mask:0xf bank_mask:0xf
  v_add_f32_dpp v45, v45, v45 row_ror:8 row_mask:0xf bank_mask:0xf
  v_add_f32_dpp v46, v46, v46 row_ror:8 row_mask:0xf bank_mask:0xf
  v_add_f32_dpp v47, v47, v47 row_ror:8 row_mask:0xf bank_mask:0xf
  v_cvt_pk_bf16_f32 v24, v40, v41
  v_cvt_pk_bf16_f32 v25, v42, v43
  v_cvt_pk_bf16_f32 v26, v44, v45
  v_cvt_pk_bf16_f32 v27, v46, v47
  s_mov_b32 exec_lo, 0x00030003
  s_mov_b32 exec_hi, 0x00030003
  ds_write_b64 v7, v[24:25] offset:1952
  ds_write_b64 v7, v[26:27] offset:2016
  s_mov_b64 exec, 1
  ds_add_u32 v3, v38 offset:32
  s_mov_b64 exec, -1
  s_branch L_KV_END
L_KVB:
  s_mov_b32 s52, s8
  s_and_b32 s53, s9, 0xffff
  s_mov_b32 s54, 0x1000
  s_mov_b32 s55, 0x20000
  s_mov_b32 s60, s26
  s_and_b32 s61, s27, 0xffff
  s_mov_b32 s62, 0x400
  s_mov_b32 s63, 0x20000
  s_sub_u32 s86, s39, 4
  s_lshl_b32 s85, s86, 10
  v_lshlrev_b32 v36, 4, v0
  buffer_load_dwordx4 v[28:31], v36, s[52:55], s85 offen
  buffer_load_dwordx4 v[32:35], v36, s[60:63], 0 offen
  s_setprio 2
  s_waitcnt vmcnt(10)
  v_perm_b32 v40, v108, v104, s74
  v_perm_b32 v41, v116, v112, s74
  v_perm_b32 v42, v124, v120, s74
  v_perm_b32 v43, v132, v128, s74
  v_perm_b32 v44, v108, v104, s75
  v_perm_b32 v45, v116, v112, s75
  v_perm_b32 v46, v124, v120, s75
  v_perm_b32 v47, v132, v128, s75
  v_mfma_f32_16x16x32_bf16 v[72:75], v[8:11], v[40:43], 0
  v_perm_b32 v48, v109, v105, s74
  v_perm_b32 v49, v117, v113, s74
  v_perm_b32 v50, v125, v121, s74
  v_perm_b32 v51, v133, v129, s74
  v_mfma_f32_16x16x32_bf16 v[76:79], v[8:11], v[44:47], 0
  v_perm_b32 v52, v109, v105, s75
  v_perm_b32 v53, v117, v113, s75
  v_perm_b32 v54, v125, v121, s75
  v_perm_b32 v55, v133, v129, s75
  v_mfma_f32_16x16x32_bf16 v[80:83], v[8:11], v[48:51], 0
  v_perm_b32 v56, v110, v106, s74
  v_perm_b32 v57, v118, v114, s74
  v_perm_b32 v58, v126, v122, s74
  v_perm_b32 v59, v134, v130, s74
  v_mfma_f32_16x16x32_bf16 v[84:87], v[8:11], v[52:55], 0
  v_perm_b32 v60, v110, v106, s75
  v_perm_b32 v61, v118, v114, s75
  v_perm_b32 v62, v126, v122, s75
  v_perm_b32 v63, v134, v130, s75
  v_mfma_f32_16x16x32_bf16 v[88:91], v[8:11], v[56:59], 0
  v_perm_b32 v64, v111, v107, s74
  v_perm_b32 v65, v119, v115, s74
  v_perm_b32 v66, v127, v123, s74
  v_perm_b32 v67, v135, v131, s74
  v_mfma_f32_16x16x32_bf16 v[92:95], v[8:11], v[60:63], 0
  v_perm_b32 v68, v111, v107, s75
  v_perm_b32 v69, v119, v115, s75
  v_perm_b32 v70, v127, v123, s75
  v_perm_b32 v71, v135, v131, s75
  v_mfma_f32_16x16x32_bf16 v[96:99], v[8:11], v[64:67], 0
  s_nop 1
  v_mfma_f32_16x16x32_bf16 v[100:103], v[8:11], v[68:71], 0
  s_mov_b32 s84, 1048576
L_spin_59:
  ds_read_b32 v36, v3 offset:16
  s_waitcnt lgkmcnt(0)
  v_readfirstlane_b32 s85, v36
  s_cmp_ge_u32 s85, 8
  s_cbranch_scc1 L_spind_60
  s_sleep 1
  s_sub_u32 s84, s84, 1
  s_cmp_lg_u32 s84, 0
  s_cbranch_scc1 L_spin_59
L_spind_60:
  v_lshrrev_b32 v6, 4, v0
  v_lshlrev_b32 v6, 5, v6
  ds_read_b128 v[16:19], v6 offset:256
  ds_read_b128 v[20:23], v6 offset:272
  s_lshl_b32 s85, s39, 2
  v_add_u32 v7, s85, v6
  ds_read_b32 v24, v7 offset:256
  s_waitcnt lgkmcnt(0)
  v_max3_f32 v16, v16, v17, v18
  v_max3_f32 v19, v19, v20, v21
  v_max3_f32 v16, v16, v22, v23
  v_max_f32 v16, v16, v19
  v_sub_f32 v24, v24, v16
  v_mul_f32 v24, s92, v24
  v_exp_f32 v24, v24
  v_lshrrev_b32 v6, 4, v0
  v_lshlrev_b32 v6, 9, v6
  v_and_b32 v7, 15, v0
  v_lshlrev_b32 v7, 4, v7
  s_lshl_b32 s85, s39, 11
  v_add3_u32 v6, v6, v7, s85
  s_waitcnt vmcnt(8)
  v_perm_b32 v40, v140, v136, s74
  v_perm_b32 v44, v140, v136, s75
  v_perm_b32 v48, v141, v137, s74
  v_perm_b32 v52, v141, v137, s75
  v_perm_b32 v56, v142, v138, s74
  v_perm_b32 v60, v142, v138, s75
  v_perm_b32 v64, v143, v139, s74
  v_perm_b32 v68, v143, v139, s75
  s_waitcnt vmcnt(6)
  v_perm_b32 v41, v148, v144, s74
  v_perm_b32 v45, v148, v144, s75
  v_perm_b32 v49, v149, v145, s74
  v_perm_b32 v53, v149, v145, s75
  v_perm_b32 v57, v150, v146, s74
  v_perm_b32 v61, v150, v146, s75
  v_perm_b32 v65, v151, v147, s74
  v_perm_b32 v69, v151, v147, s75
  s_waitcnt vmcnt(4)
  v_perm_b32 v42, v156, v152, s74
  v_perm_b32 v46, v156, v152, s75
  v_perm_b32 v50, v157, v153, s74
  v_perm_b32 v54, v157, v153, s75
  v_perm_b32 v58, v158, v154, s74
  v_perm_b32 v62, v158, v154, s75
  v_perm_b32 v66, v159, v155, s74
  v_perm_b32 v70, v159, v155, s75
  s_waitcnt vmcnt(2)
  v_perm_b32 v43, v164, v160, s74
  v_perm_b32 v47, v164, v160, s75
  v_perm_b32 v51, v165, v161, s74
  v_perm_b32 v55, v165, v161, s75
  v_perm_b32 v59, v166, v162, s74
  v_perm_b32 v63, v166, v162, s75
  v_perm_b32 v67, v167, v163, s74
  v_perm_b32 v71, v167, v163, s75
  s_nop 1
  v_mfma_f32_16x16x32_bf16 v[72:75], v[12:15], v[40:43], v[72:75]
  v_mfma_f32_16x16x32_bf16 v[76:79], v[12:15], v[44:47], v[76:79]
  v_mfma_f32_16x16x32_bf16 v[80:83], v[12:15], v[48:51], v[80:83]
  v_mfma_f32_16x16x32_bf16 v[84:87], v[12:15], v[52:55], v[84:87]
  v_mfma_f32_16x16x32_bf16 v[88:91], v[12:15], v[56:59], v[88:91]
  v_mfma_f32_16x16x32_bf16 v[92:95], v[12:15], v[60:63], v[92:95]
  v_mfma_f32_16x16x32_bf16 v[96:99], v[12:15], v[64:67], v[96:99]
  v_mfma_f32_16x16x32_bf16 v[100:103], v[12:15], v[68:71], v[100:103]
  s_nop 7
  v_mul_f32 v16, v24, v72
  v_mul_f32 v17, v24, v76
  v_mul_f32 v18, v24, v80
  v_mul_f32 v19, v24, v84
  v_mul_f32 v20, v24, v88
  v_mul_f32 v21, v24, v92
  v_mul_f32 v22, v24, v96
  v_mul_f32 v23, v24, v100
  ds_write_b128 v6, v[16:19] offset:10752
  ds_write_b128 v6, v[20:23] offset:11008
  s_mov_b64 exec, 1
  ds_add_u32 v3, v38 offset:20
  s_mov_b64 exec, -1
  s_waitcnt vmcnt(0)
  v_lshlrev_b32 v8, 16, v28
  v_and_b32 v9, 0xffff0000, v28
  v_lshlrev_b32 v10, 16, v32
  v_and_b32 v11, 0xffff0000, v32
  v_mul_f32 v8, v8, v10
  v_mul_f32 v9, v9, v11
  v_cvt_pk_bf16_f32 v10, v8, v9
  v_lshlrev_b32 v8, 16, v10
  v_and_b32 v9, 0xffff0000, v10
  v_add_f32 v12, v8, v9
  v_lshlrev_b32 v8, 16, v29
  v_and_b32 v9, 0xffff0000, v29
  v_lshlrev_b32 v10, 16, v33
  v_and_b32 v11, 0xffff0000, v33
  v_mul_f32 v8, v8, v10
  v_mul_f32 v9, v9, v11
  v_cvt_pk_bf16_f32 v10, v8, v9
  v_lshlrev_b32 v8, 16, v10
  v_and_b32 v9, 0xffff0000, v10
  v_add_f32 v8, v8, v9
  v_add_f32 v12, v12, v8
  v_lshlrev_b32 v8, 16, v30
  v_and_b32 v9, 0xffff0000, v30
  v_lshlrev_b32 v10, 16, v34
  v_and_b32 v11, 0xffff0000, v34
  v_mul_f32 v8, v8, v10
  v_mul_f32 v9, v9, v11
  v_cvt_pk_bf16_f32 v10, v8, v9
  v_lshlrev_b32 v8, 16, v10
  v_and_b32 v9, 0xffff0000, v10
  v_add_f32 v8, v8, v9
  v_add_f32 v12, v12, v8
  v_lshlrev_b32 v8, 16, v31
  v_and_b32 v9, 0xffff0000, v31
  v_lshlrev_b32 v10, 16, v35
  v_and_b32 v11, 0xffff0000, v35
  v_mul_f32 v8, v8, v10
  v_mul_f32 v9, v9, v11
  v_cvt_pk_bf16_f32 v10, v8, v9
  v_lshlrev_b32 v8, 16, v10
  v_and_b32 v9, 0xffff0000, v10
  v_add_f32 v8, v8, v9
  v_add_f32 v12, v12, v8
  s_nop 1
  v_add_f32_dpp v12, v12, v12 row_ror:8 row_mask:0xf bank_mask:0xf
  s_nop 1
  v_add_f32_dpp v12, v12, v12 row_ror:4 row_mask:0xf bank_mask:0xf
  s_nop 1
  v_add_f32_dpp v12, v12, v12 row_ror:2 row_mask:0xf bank_mask:0xf
  s_nop 1
  v_add_f32_dpp v12, v12, v12 row_ror:1 row_mask:0xf bank_mask:0xf
  v_mov_b32 v13, v12
  s_nop 1
  v_permlane16_swap_b32 v12, v13
  s_nop 0
  v_add_f32 v12, v12, v13
  v_mov_b32 v13, v12
  s_nop 1
  v_permlane32_swap_b32 v12, v13
  s_nop 0
  v_add_f32 v12, v12, v13
  v_cvt_pk_bf16_f32 v12, v12, v12
  v_lshlrev_b32 v12, 16, v12
  v_mul_f32 v12, s92, v12
  v_exp_f32 v12, -v12
  s_nop 0
  v_add_f32 v12, 1.0, v12
  v_rcp_f32 v12, v12
  s_nop 0
  v_cvt_pk_bf16_f32 v12, v12, v12
  v_lshlrev_b32 v14, 16, v12
  v_sub_f32 v12, 1.0, v14
  v_cvt_pk_bf16_f32 v12, v12, v12
  v_lshlrev_b32 v15, 16, v12
  s_sub_u32 s86, s39, 4
  s_lshl_b32 s85, s86, 3
  v_mov_b32 v12, s85
  s_mov_b64 exec, 1
  ds_write_b64 v12, v[14:15] offset:1920
  ds_add_u32 v3, v38 offset:36
  s_mov_b64 exec, -1
L_KV_END:
  s_waitcnt lgkmcnt(0)
  s_endpgm
L_END:
  s_endpgm
.section .rodata,"a"
.p2align 6
.amdhsa_kernel gated_mix__gqa_block_cached__swiglu_ffn__decode_kernel
  .amdhsa_next_free_vgpr 168
  .amdhsa_next_free_sgpr 102
  .amdhsa_accum_offset 168
  .amdhsa_group_segment_fixed_size 0
  .amdhsa_kernarg_size 104
  .amdhsa_user_sgpr_count 2
  .amdhsa_user_sgpr_kernarg_segment_ptr 1
  .amdhsa_system_sgpr_workgroup_id_x 1
.end_amdhsa_kernel
```
